```python
import torch

def _softmax(x, axis=-1):
    return torch.softmax(x, dim=axis)
def _gelu(x):
    return torch.nn.functional.gelu(x, approximate="tanh")
def _silu(x):
    return torch.nn.functional.silu(x)
def _sigmoid(x):
    return torch.sigmoid(x)
def _layernorm(x, axis=-1, eps=1e-5):
    m = x.mean(dim=axis, keepdim=True)
    v = x.var(dim=axis, keepdim=True, unbiased=False)
    return (x - m) / torch.sqrt(v + eps)
def _scatter_add(tgt, idx, src, axis=0):
    return tgt.clone().index_add_(axis, idx, src)
def _segment_sum(src, seg, n):
    out = torch.zeros((n,) + src.shape[1:], dtype=src.dtype)
    return out.index_add_(0, seg, src)
def _pad(x, pw):
    flat = tuple(v for pair in reversed(pw) for v in pair)
    return torch.nn.functional.pad(x, flat)

kernel_name = 'sequential_preLN__sliding_block_cached__glu_gated_glu__decode'

def setup_inputs():

    _w = (lambda a: (lambda t: t.to(torch.bfloat16) if t.is_floating_point() else t)(torch.as_tensor(a)))
    def _A_setup():
        B, Sq, D = 1, 1, 640
        Hq, Hkv, Sk, Dh = 32, 32, 8192, 192
        assert Hq % Hkv == 0, (Hq, Hkv)
        return {
            "x": _w((lambda *s: torch.randn(*s, dtype=torch.bfloat16) * 0.05)(B, Sq, D)),
            "k_cache": _w((lambda *s: torch.randn(*s, dtype=torch.bfloat16) * 3.2)(B, Hkv, Sk, Dh)),
            "v_cache": _w((lambda *s: torch.randn(*s, dtype=torch.bfloat16) * 0.4)(B, Hkv, Sk, Dh)),
            "wq": _w((lambda *s: torch.randn(*s, dtype=torch.bfloat16) * 3.2)(D, Hq * Dh) * (D ** -0.5)),
            "wo": _w((lambda *s: torch.randn(*s, dtype=torch.bfloat16) * 0.4)(Hq * Dh, D) * ((Hq * Dh) ** -0.5)),
        }
    _A_in = _A_setup()

    def _B_setup():
        B, S, D, F = 1, 1, 640, 1536
        return {
            "x": _w((lambda *s: torch.randn(*s, dtype=torch.bfloat16) * 0.05)(B, S, D)),
            "w_gate": _w((lambda *s: torch.randn(*s, dtype=torch.bfloat16) * 0.05)(D, F)),
            "w_up": _w((lambda *s: torch.randn(*s, dtype=torch.bfloat16) * 0.05)(D, F)),
            "w_down": _w((lambda *s: torch.randn(*s, dtype=torch.bfloat16) * 0.05)(F, D)),
        }
    _B_in = _B_setup()

    return {
        "A_x": _A_in["x"],
        "A_k_cache": _A_in["k_cache"],
        "A_v_cache": _A_in["v_cache"],
        "A_wq": _A_in["wq"],
        "A_wo": _A_in["wo"],
        "B_x": _B_in["x"],
        "B_w_gate": _B_in["w_gate"],
        "B_w_up": _B_in["w_up"],
        "B_w_down": _B_in["w_down"],
    }

def reference(A_x, A_k_cache, A_v_cache, A_wq, A_wo, B_x, B_w_gate, B_w_up, B_w_down):
    def _A_ref(x, k_cache, v_cache, wq, wo):
        B, Sq, D = x.shape
        Hq, Dh = 32, 192
        Hkv, Sk = k_cache.shape[1], k_cache.shape[2]
        W = min(4096, max(256, Sk // 4))
        rep = Hq // Hkv
        q = (lambda x, *d: x.permute(*d))((x @ wq).reshape(B, Sq, Hq, Dh), 0, 2, 1, 3)
        k = (lambda x, n, axis: torch.repeat_interleave(x, n, dim=axis))(k_cache[:, :, Sk - W:, :], rep, axis=1)
        v = (lambda x, n, axis: torch.repeat_interleave(x, n, dim=axis))(v_cache[:, :, Sk - W:, :], rep, axis=1)
        scores = torch.einsum("bhqd,bhkd->bhqk", q, k) * (Dh ** -0.5)
        p = _softmax(scores, axis=-1)
        o = torch.einsum("bhqk,bhkd->bhqd", p, v)
        return (lambda x, *d: x.permute(*d))(o, 0, 2, 1, 3).reshape(B, Sq, Hq * Dh) @ wo

    def _B_ref(x, w_gate, w_up, w_down):
        g = torch.einsum("bsd,df->bsf", x, w_gate)
        u = torch.einsum("bsd,df->bsf", x, w_up)
        h = _sigmoid(g) * u
        return torch.einsum("bsf,fd->bsd", h, w_down)

    x = A_x
    h = x + _A_ref(_layernorm(x, axis=-1), A_k_cache, A_v_cache, A_wq, A_wo)
    h2 = h + _B_ref(_layernorm(h, axis=-1), B_w_gate, B_w_up, B_w_down)
    return h2
```

```asm
; @launch grid=(256,1,1) block=(640,1,1) lds=163840
.amdgcn_target "amdgcn-amd-amdhsa--gfx950"
.text
.globl sequential_preLN__sliding_block_cached__glu_gated_glu__decode_kernel
.p2align 8
.type sequential_preLN__sliding_block_cached__glu_gated_glu__decode_kernel,@function
sequential_preLN__sliding_block_cached__glu_gated_glu__decode_kernel:
    s_cmp_ge_u32 s2, 256
    s_cbranch_scc1 L_END0
    s_load_dwordx16 s[68:83], s[0:1], 0
    s_load_dwordx8 s[84:91], s[0:1], 64
    v_lshrrev_b32 v1, 6, v0
    v_and_b32 v0, 63, v0
    s_and_b32 s4, s2, 7
    v_readfirstlane_b32 s3, v1
    s_lshr_b32 s5, s2, 3
    s_mul_i32 s16, s5, 37
    s_lshr_b32 s16, s16, 8
    s_mul_i32 s17, s16, 7
    s_sub_u32 s7, s5, s17
    s_lshl_b32 s6, s4, 2
    s_add_u32 s6, s6, s16
    s_cmp_lt_u32 s7, 2
    s_cselect_b32 s8, 38, 36
    s_min_u32 s16, s7, 2
    s_lshl_b32 s16, s16, 1
    s_mul_i32 s9, s7, 36
    s_add_u32 s9, s9, s16
    s_sub_i32 s16, s7, 2
    s_cmp_lt_u32 s16, 3
    s_cselect_b32 s10, 12, 11
    s_cselect_b32 s12, 4, 3
    s_max_i32 s16, s16, 0
    s_min_i32 s16, s16, 3
    s_mul_i32 s11, s7, 11
    s_add_u32 s11, s11, s16
    s_mul_i32 s13, s7, 3
    s_add_u32 s13, s13, s16
    s_mov_b32 s14, 0x40000
    s_mov_b32 s15, 0
    s_mov_b32 s26, 1280
    s_mov_b32 s27, 0x20000
    s_mov_b32 s30, 100663296
    s_mov_b32 s31, 0x20000
    s_mov_b32 s34, 100663296
    s_mov_b32 s35, 0x20000
    s_mov_b32 s38, 7864320
    s_mov_b32 s39, 0x20000
    s_mov_b32 s42, 7864320
    s_mov_b32 s43, 0x20000
    s_mov_b32 s46, 1966080
    s_mov_b32 s47, 0x20000
    s_mov_b32 s50, 1966080
    s_mov_b32 s51, 0x20000
    s_mov_b32 s54, 1966080
    s_mov_b32 s55, 0x20000
    s_mov_b32 s58, 1280
    s_mov_b32 s59, 0x20000
    s_mov_b32 s62, 256
    s_mov_b32 s63, 0x20000
    s_mov_b32 s66, 402653184
    s_mov_b32 s67, 0x20000
    v_mov_b32 v2, 160064
    v_lshlrev_b32 v3, 2, v0
    s_sub_u32 s20, s3, 2
    v_lshrrev_b32 v5, 3, v0
    v_mul_u32_u24 v5, 384, v5
    v_and_b32 v4, 7, v0
    v_lshl_add_u32 v5, v4, 4, v5
    s_mul_i32 s21, s6, 3145728
    s_add_u32 s22, s9, s20
    s_mul_i32 s22, s22, 3072
    s_add_u32 s21, s21, s22
    s_add_u32 s21, s21, 2359296
    s_add_u32 s22, s20, 32
    s_cmp_lt_u32 s22, s8
    s_cselect_b32 s23, 1, 0
    v_lshrrev_b32 v33, 5, v0
    v_lshlrev_b32 v33, 2, v33
    v_bfe_u32 v34, v0, 2, 2
    v_or_b32 v33, v33, v34
    v_mul_u32_u24 v30, 12288, v33
    v_bfe_u32 v34, v0, 4, 1
    v_lshl_add_u32 v30, v34, 6, v30
    v_and_b32 v34, 3, v0
    v_lshl_add_u32 v30, v34, 4, v30
    v_add_u32 v31, 128, v30
    v_add_u32 v32, 256, v30
    s_mul_i32 s16, s3, 6
    s_add_u32 s17, s11, s16
    s_mul_i32 s17, s17, 98304
    s_mul_i32 s18, s6, 384
    s_add_u32 s17, s17, s18
    s_mul_i32 s16, s16, 3072
    s_add_u32 m0, s16, 116736
    s_waitcnt lgkmcnt(0)
    s_mov_b32 s24, s68
    s_and_b32 s25, s69, 0xffff
    s_mov_b32 s28, s70
    s_and_b32 s29, s71, 0xffff
    s_mov_b32 s32, s72
    s_and_b32 s33, s73, 0xffff
    s_mov_b32 s36, s74
    s_and_b32 s37, s75, 0xffff
    s_mov_b32 s40, s76
    s_and_b32 s41, s77, 0xffff
    s_mov_b32 s44, s80
    s_and_b32 s45, s81, 0xffff
    s_mov_b32 s48, s82
    s_and_b32 s49, s83, 0xffff
    s_mov_b32 s52, s84
    s_and_b32 s53, s85, 0xffff
    s_mov_b32 s56, s86
    s_and_b32 s57, s87, 0xffff
    s_mov_b32 s60, s88
    s_and_b32 s61, s89, 0xffff
    s_mov_b32 s64, s90
    s_and_b32 s65, s91, 0xffff
    s_cmp_ge_u32 s5, 28
    s_cbranch_scc1 L_FROLE
    s_cmp_lt_u32 s3, 2
    s_cbranch_scc1 L_ST2
    buffer_load_dwordx4 v[40:43], v5, s[28:31], s21 offen offset:0 nt
    buffer_load_dwordx4 v[44:47], v5, s[28:31], s21 offen offset:128 nt
    buffer_load_dwordx4 v[48:51], v5, s[28:31], s21 offen offset:256 nt
    s_add_u32 s21, s21, 24576
    v_mov_b32 v3, v5
    s_barrier
    s_branch L_COMPUTE
L_ST2:
    s_mov_b32 s21, 6
    s_cmp_eq_u32 s3, 0
    s_cbranch_scc1 L_ST3
    buffer_load_dword v8, v3, s[24:27], 0 offen offset:0
    buffer_load_dword v9, v3, s[24:27], 0 offen offset:256
    buffer_load_dword v10, v3, s[24:27], 0 offen offset:512
    buffer_load_dword v11, v3, s[24:27], 0 offen offset:768
    buffer_load_dword v12, v3, s[24:27], 0 offen offset:1024
    s_lshl_b32 s16, s12, 2
    v_cmp_gt_u32 vcc, s16, v0
    v_add_u32 v5, 160000, v3
    v_mov_b32 v6, 0
    v_mov_b32 v7, -1
    v_cndmask_b32 v1, v6, v7, vcc
    s_mov_b32 exec_lo, 0xffffffff
    s_mov_b32 exec_hi, 0
    ds_write_b32 v5, v1
    s_mov_b64 exec, -1
    s_sub_u32 s21, s10, 6
    s_waitcnt lgkmcnt(0)
L_ST3:
    s_barrier
L_ST4:
    buffer_load_dwordx4 v30, s[36:39], s17 offen nt lds
    s_add_u32 m0, m0, 1024
    s_nop 0
    buffer_load_dwordx4 v31, s[36:39], s17 offen nt lds
    s_add_u32 m0, m0, 1024
    s_nop 0
    buffer_load_dwordx4 v32, s[36:39], s17 offen nt lds
    s_add_u32 m0, m0, 1024
    s_add_u32 s17, s17, 98304
    s_sub_u32 s21, s21, 1
    s_cmp_lg_u32 s21, 0
    s_cbranch_scc1 L_ST4
    s_cmp_eq_u32 s3, 0
    s_cbranch_scc1 L_LOADER
    s_branch L_COMM
L_FROLE:
    v_mov_b32 v16, -1
    v_mov_b32 v17, -1
    v_mov_b32 v18, -1
    v_mov_b32 v19, -1
    v_lshlrev_b32 v4, 4, v0
    v_lshl_add_u32 v6, s3, 10, v4
    s_sub_u32 s70, s5, 28
    s_mul_i32 s20, s4, 3
    s_add_u32 s20, s20, s70
    s_getreg_b32 s68, hwreg(HW_REG_XCC_ID)
    s_and_b32 s68, s68, 15
    s_add_u32 s68, s68, 1
    v_mov_b32 v1, 0
    v_add_u32 v5, 153600, v3
    ds_write_b32 v5, v1
    v_mov_b32 v2, 153856
    ds_write_b32 v2, v1
    s_cmp_eq_u32 s5, 31
    s_cbranch_scc1 LD_2
    s_lshl_b32 s22, s4, 2
    s_add_u32 s22, s22, s70
    s_lshl_b32 s23, s22, 13
    s_lshl_b32 s17, s3, 10
    s_add_u32 s17, s17, s23
    s_lshl_b32 s18, s22, 10
    s_add_u32 s18, s18, 262144
    s_cmp_ge_u32 s3, 8
    s_cselect_b32 s17, s18, s17
    buffer_store_dwordx4 v[16:19], v4, s[64:67], s17 offen sc1
    s_cmp_ge_u32 s3, 6
    s_cbranch_scc1 LD_3
    s_add_u32 s17, s23, 327680
    buffer_store_dwordx4 v[16:19], v6, s[64:67], s17 offen sc1
LD_3:
    s_cmp_lg_u32 s3, 9
    s_cbranch_scc1 LD_4
    s_lshl_b32 s17, s4, 12
    s_mul_i32 s19, s70, 640
    s_add_u32 s17, s17, s19
    s_add_u32 s17, s17, 1179648
    s_mov_b32 exec_lo, -1
    s_mov_b32 exec_hi, 0xff
    buffer_store_dwordx4 v[16:19], v4, s[64:67], s17 offen sc1
    s_mov_b64 exec, -1
LD_4:
    s_cmp_eq_u32 s70, 3
    s_cbranch_scc1 LD_5
    s_mul_i32 s17, s4, 3
    s_add_u32 s17, s17, s70
    s_mul_i32 s17, s17, 2560
    s_lshl_b32 s18, s3, 8
    s_add_u32 s17, s17, s18
    s_add_u32 s17, s17, 1245184
    s_mov_b32 exec_lo, 0xffff
    s_mov_b32 exec_hi, 0
    buffer_store_dwordx4 v[16:19], v4, s[64:67], s17 offen sc1
    s_mov_b64 exec, -1
LD_5:
    s_waitcnt vmcnt(0) lgkmcnt(0)
    s_barrier
    s_cmp_lg_u32 s3, 0
    s_cbranch_scc1 LD_6
    v_mov_b32 v1, s68
    s_mov_b64 exec, 1
    s_lshl_b32 s17, s4, 2
    s_add_u32 s17, s17, s70
    s_lshl_b32 s17, s17, 3
    v_mov_b32 v5, s17
    buffer_store_dword v1, v5, s[60:63], 0 offen offset:0 sc1
    s_mov_b64 exec, -1
LD_6:
    s_branch LD_1
LD_2:
    s_lshl_b32 s22, s4, 2
    s_add_u32 s22, s22, s70
    s_lshl_b32 s23, s22, 13
    s_lshl_b32 s17, s3, 10
    s_add_u32 s17, s17, s23
    s_lshl_b32 s18, s22, 10
    s_add_u32 s18, s18, 262144
    s_cmp_ge_u32 s3, 8
    s_cselect_b32 s17, s18, s17
    buffer_store_dwordx4 v[16:19], v4, s[64:67], s17 offen sc1
    s_cmp_ge_u32 s3, 6
    s_cbranch_scc1 LD_7
    s_add_u32 s17, s23, 327680
    buffer_store_dwordx4 v[16:19], v6, s[64:67], s17 offen sc1
LD_7:
    s_cmp_lg_u32 s3, 9
    s_cbranch_scc1 LD_8
    s_lshl_b32 s17, s4, 12
    s_mul_i32 s19, s70, 640
    s_add_u32 s17, s17, s19
    s_add_u32 s17, s17, 1179648
    s_mov_b32 exec_lo, -1
    s_mov_b32 exec_hi, 0xff
    buffer_store_dwordx4 v[16:19], v4, s[64:67], s17 offen sc1
    s_mov_b64 exec, -1
LD_8:
    s_cmp_eq_u32 s70, 3
    s_cbranch_scc1 LD_9
    s_mul_i32 s17, s4, 3
    s_add_u32 s17, s17, s70
    s_mul_i32 s17, s17, 2560
    s_lshl_b32 s18, s3, 8
    s_add_u32 s17, s17, s18
    s_add_u32 s17, s17, 1245184
    s_mov_b32 exec_lo, 0xffff
    s_mov_b32 exec_hi, 0
    buffer_store_dwordx4 v[16:19], v4, s[64:67], s17 offen sc1
    s_mov_b64 exec, -1
LD_9:
    s_mov_b32 s69, 3
    s_waitcnt vmcnt(0) lgkmcnt(0)
    s_barrier
    s_cmp_lg_u32 s3, 0
    s_cbranch_scc1 LD_10
    v_mov_b32 v1, s68
    s_mov_b64 exec, 1
    s_lshl_b32 s17, s4, 2
    s_add_u32 s17, s17, s70
    s_lshl_b32 s17, s17, 3
    v_mov_b32 v5, s17
    buffer_store_dword v1, v5, s[60:63], 0 offen offset:0 sc1
    s_lshl_b32 s17, s4, 2
    s_add_u32 s17, s17, s69
    s_lshl_b32 s17, s17, 3
    v_mov_b32 v5, s17
    buffer_store_dword v1, v5, s[60:63], 0 offen offset:0 sc1
    s_mov_b64 exec, -1
LD_10:
    s_mul_i32 s17, s4, 73728
    s_add_u32 s17, s17, 589824
    buffer_store_dwordx4 v[16:19], v6, s[64:67], s17 offen sc1
    s_add_u32 s17, s17, 10240
    buffer_store_dwordx4 v[16:19], v6, s[64:67], s17 offen sc1
    s_add_u32 s17, s17, 10240
    buffer_store_dwordx4 v[16:19], v6, s[64:67], s17 offen sc1
    s_add_u32 s17, s17, 10240
    buffer_store_dwordx4 v[16:19], v6, s[64:67], s17 offen sc1
    s_add_u32 s17, s17, 10240
    buffer_store_dwordx4 v[16:19], v6, s[64:67], s17 offen sc1
    s_add_u32 s17, s17, 10240
    buffer_store_dwordx4 v[16:19], v6, s[64:67], s17 offen sc1
    s_add_u32 s17, s17, 10240
    buffer_store_dwordx4 v[16:19], v6, s[64:67], s17 offen sc1
    s_add_u32 s17, s17, 10240
    s_waitcnt vmcnt(0) lgkmcnt(0)
    s_barrier
    s_cmp_lg_u32 s3, 0
    s_cbranch_scc1 LD_11
    v_mov_b32 v1, 1
    s_mov_b64 exec, 1
    s_lshl_b32 s17, s4, 2
    s_add_u32 s17, s17, s70
    s_lshl_b32 s17, s17, 3
    v_mov_b32 v5, s17
    buffer_store_dword v1, v5, s[60:63], 0 offen offset:4 sc1
    s_mov_b64 exec, -1
LD_11:
    s_branch L_END
LD_1:
    s_mul_i32 s21, s20, 2560
    s_lshl_b32 s17, s3, 8
    s_add_u32 s21, s21, s17
    s_add_u32 s21, s21, 1245184
    v_mov_b32 v39, v4
    v_lshlrev_b32 v4, 1, v0
    s_lshl_b32 s17, s3, 7
    buffer_load_ushort v20, v4, s[24:27], s17 offen
    v_lshrrev_b32 v8, 5, v0
    v_lshlrev_b32 v8, 2, v8
    v_bfe_u32 v9, v0, 2, 2
    v_or_b32 v8, v8, v9
    v_mul_u32_u24 v5, 3072, v8
    v_bfe_u32 v9, v0, 4, 1
    v_lshl_add_u32 v5, v9, 6, v5
    v_and_b32 v9, 3, v0
    v_lshl_add_u32 v5, v9, 4, v5
    v_lshrrev_b32 v8, 5, v0
    v_lshlrev_b32 v8, 2, v8
    v_bfe_u32 v9, v0, 2, 2
    v_or_b32 v8, v8, v9
    v_mul_u32_u24 v6, 1280, v8
    v_bfe_u32 v9, v0, 4, 1
    v_lshl_add_u32 v6, v9, 6, v6
    v_and_b32 v9, 3, v0
    v_lshl_add_u32 v6, v9, 4, v6
    v_lshrrev_b32 v7, 5, v0
    v_lshlrev_b32 v7, 8, v7
    v_bfe_u32 v8, v0, 2, 2
    v_lshl_add_u32 v7, v8, 6, v7
    v_bfe_u32 v8, v0, 4, 1
    v_lshl_add_u32 v7, v8, 5, v7
    v_and_b32 v8, 3, v0
    v_lshl_add_u32 v7, v8, 3, v7
    s_mul_i32 s22, s3, 14336
    v_add_u32 v7, s22, v7
    s_mul_i32 s17, s3, 196608
    s_lshl_b32 s18, s20, 7
    s_add_u32 s68, s17, s18
    s_mul_i32 s17, s20, 81920
    s_lshl_b32 s18, s3, 7
    s_add_u32 s69, s17, s18
    s_add_u32 m0, s22, 8192
    s_add_u32 s17, s68, 0
    buffer_load_dwordx4 v5, s[44:47], s17 offen nt lds
    s_add_u32 m0, s22, 9216
    s_add_u32 s17, s68, 24576
    buffer_load_dwordx4 v5, s[44:47], s17 offen nt lds
    s_add_u32 m0, s22, 10240
    s_add_u32 s17, s68, 49152
    buffer_load_dwordx4 v5, s[44:47], s17 offen nt lds
    s_add_u32 m0, s22, 11264
    s_add_u32 s17, s68, 73728
    buffer_load_dwordx4 v5, s[44:47], s17 offen nt lds
    s_waitcnt vmcnt(3)
    ds_read_b64_tr_b16 v[40:41], v7 offset:8192
    ds_read_b64_tr_b16 v[42:43], v7 offset:8704
    s_add_u32 m0, s22, 12288
    s_add_u32 s17, s68, 98304
    buffer_load_dwordx4 v5, s[44:47], s17 offen nt lds
    s_waitcnt vmcnt(3)
    ds_read_b64_tr_b16 v[44:45], v7 offset:9216
    ds_read_b64_tr_b16 v[46:47], v7 offset:9728
    s_add_u32 m0, s22, 13312
    s_add_u32 s17, s68, 122880
    buffer_load_dwordx4 v5, s[44:47], s17 offen nt lds
    s_waitcnt vmcnt(3)
    ds_read_b64_tr_b16 v[48:49], v7 offset:10240
    ds_read_b64_tr_b16 v[50:51], v7 offset:10752
    s_add_u32 m0, s22, 8192
    s_add_u32 s17, s68, 147456
    s_waitcnt lgkmcnt(2)
    buffer_load_dwordx4 v5, s[44:47], s17 offen nt lds
    s_waitcnt vmcnt(3)
    ds_read_b64_tr_b16 v[52:53], v7 offset:11264
    ds_read_b64_tr_b16 v[54:55], v7 offset:11776
    s_add_u32 m0, s22, 9216
    s_add_u32 s17, s68, 172032
    s_waitcnt lgkmcnt(2)
    buffer_load_dwordx4 v5, s[44:47], s17 offen nt lds
    s_waitcnt vmcnt(3)
    ds_read_b64_tr_b16 v[56:57], v7 offset:12288
    ds_read_b64_tr_b16 v[58:59], v7 offset:12800
    s_add_u32 m0, s22, 10240
    s_add_u32 s17, s68, 0
    s_waitcnt lgkmcnt(2)
    buffer_load_dwordx4 v5, s[48:51], s17 offen nt lds
    s_waitcnt vmcnt(3)
    ds_read_b64_tr_b16 v[60:61], v7 offset:13312
    ds_read_b64_tr_b16 v[62:63], v7 offset:13824
    s_add_u32 m0, s22, 11264
    s_add_u32 s17, s68, 24576
    s_waitcnt lgkmcnt(2)
    buffer_load_dwordx4 v5, s[48:51], s17 offen nt lds
    s_waitcnt vmcnt(3)
    ds_read_b64_tr_b16 v[64:65], v7 offset:8192
    ds_read_b64_tr_b16 v[66:67], v7 offset:8704
    s_add_u32 m0, s22, 12288
    s_add_u32 s17, s68, 49152
    s_waitcnt lgkmcnt(2)
    buffer_load_dwordx4 v5, s[48:51], s17 offen nt lds
    s_waitcnt vmcnt(3)
    ds_read_b64_tr_b16 v[68:69], v7 offset:9216
    ds_read_b64_tr_b16 v[70:71], v7 offset:9728
    s_add_u32 m0, s22, 13312
    s_add_u32 s17, s68, 73728
    s_waitcnt lgkmcnt(2)
    buffer_load_dwordx4 v5, s[48:51], s17 offen nt lds
    s_waitcnt vmcnt(3)
    ds_read_b64_tr_b16 v[72:73], v7 offset:10240
    ds_read_b64_tr_b16 v[74:75], v7 offset:10752
    s_add_u32 m0, s22, 8192
    s_add_u32 s17, s68, 98304
    s_waitcnt lgkmcnt(2)
    buffer_load_dwordx4 v5, s[48:51], s17 offen nt lds
    s_waitcnt vmcnt(3)
    ds_read_b64_tr_b16 v[76:77], v7 offset:11264
    ds_read_b64_tr_b16 v[78:79], v7 offset:11776
    s_add_u32 m0, s22, 9216
    s_add_u32 s17, s68, 122880
    s_waitcnt lgkmcnt(2)
    buffer_load_dwordx4 v5, s[48:51], s17 offen nt lds
    s_waitcnt vmcnt(3)
    ds_read_b64_tr_b16 v[80:81], v7 offset:12288
    ds_read_b64_tr_b16 v[82:83], v7 offset:12800
    s_add_u32 m0, s22, 10240
    s_add_u32 s17, s68, 147456
    s_waitcnt lgkmcnt(2)
    buffer_load_dwordx4 v5, s[48:51], s17 offen nt lds
    s_waitcnt vmcnt(3)
    ds_read_b64_tr_b16 v[84:85], v7 offset:13312
    ds_read_b64_tr_b16 v[86:87], v7 offset:13824
    s_add_u32 m0, s22, 11264
    s_add_u32 s17, s68, 172032
    s_waitcnt lgkmcnt(2)
    buffer_load_dwordx4 v5, s[48:51], s17 offen nt lds
    s_waitcnt vmcnt(3)
    ds_read_b64_tr_b16 v[88:89], v7 offset:8192
    ds_read_b64_tr_b16 v[90:91], v7 offset:8704
    s_add_u32 m0, s22, 0
    s_add_u32 s17, s69, 0
    buffer_load_dwordx4 v6, s[52:55], s17 offen nt lds
    s_waitcnt vmcnt(3)
    ds_read_b64_tr_b16 v[92:93], v7 offset:9216
    ds_read_b64_tr_b16 v[94:95], v7 offset:9728
    s_add_u32 m0, s22, 1024
    s_add_u32 s17, s69, 10240
    buffer_load_dwordx4 v6, s[52:55], s17 offen nt lds
    s_waitcnt vmcnt(3)
    ds_read_b64_tr_b16 v[96:97], v7 offset:10240
    ds_read_b64_tr_b16 v[98:99], v7 offset:10752
    s_add_u32 m0, s22, 2048
    s_add_u32 s17, s69, 20480
    buffer_load_dwordx4 v6, s[52:55], s17 offen nt lds
    s_waitcnt vmcnt(3)
    ds_read_b64_tr_b16 v[100:101], v7 offset:11264
    ds_read_b64_tr_b16 v[102:103], v7 offset:11776
    s_add_u32 m0, s22, 3072
    s_add_u32 s17, s69, 30720
    buffer_load_dwordx4 v6, s[52:55], s17 offen nt lds
    s_waitcnt vmcnt(3)
    s_add_u32 m0, s22, 4096
    s_add_u32 s17, s69, 40960
    buffer_load_dwordx4 v6, s[52:55], s17 offen nt lds
    s_waitcnt vmcnt(3)
    s_add_u32 m0, s22, 5120
    s_add_u32 s17, s69, 51200
    buffer_load_dwordx4 v6, s[52:55], s17 offen nt lds
    s_waitcnt vmcnt(3)
    s_add_u32 m0, s22, 6144
    s_add_u32 s17, s69, 61440
    buffer_load_dwordx4 v6, s[52:55], s17 offen nt lds
    s_waitcnt vmcnt(3)
    s_add_u32 m0, s22, 7168
    s_add_u32 s17, s69, 71680
    buffer_load_dwordx4 v6, s[52:55], s17 offen nt lds
    s_waitcnt vmcnt(0)
    s_waitcnt lgkmcnt(0)
    s_lshl_b32 s17, s3, 8
    s_add_u32 s70, s17, 1179648
    v_add_u32 v25, 4096, v3
    v_add_u32 v26, 8192, v3
    v_add_u32 v27, 12288, v3
    v_add_u32 v28, 16384, v3
    v_add_u32 v29, 20480, v3
    v_add_u32 v30, 24576, v3
    v_add_u32 v31, 28672, v3
    v_mov_b32 v24, v3
    v_lshlrev_b32 v20, 16, v20
    s_add_u32 s17, s17, 143360
    v_add_u32 v32, s17, v3
    s_lshl_b32 s17, s3, 3
    s_add_u32 s17, s17, 153600
    v_mov_b32 v33, s17
    v_and_b32 v8, 15, v0
    v_lshrrev_b32 v9, 4, v0
    v_lshlrev_b32 v34, 3, v8
    v_add_u32 v34, 153600, v34
    v_cmp_gt_u32 vcc, 10, v8
    v_mov_b32 v10, 0
    v_mov_b32 v11, 0x42800000
    v_cndmask_b32 v5, v10, v11, vcc
    s_lshl_b32 s17, s3, 7
    s_add_u32 s17, s17, 151040
    v_add_u32 v35, s17, v4
    v_mov_b32 v36, s17
    v_add_u32 v6, 1280, v36
    v_cmp_eq_u32 vcc, v8, v9
    v_mov_b32 v10, 153728
    s_nop 0
    v_cndmask_b32 v37, v10, v36, vcc
    v_cndmask_b32 v36, v10, v6, vcc
    s_lshl_b32 s17, s3, 9
    s_add_u32 s17, s17, 145920
    v_add_u32 v38, s17, v3
    v_add_u32 v22, 145920, v3
    s_cmp_lg_u32 s3, 0
    s_cbranch_scc1 HG_12
    v_lshlrev_b32 v8, 3, v0
    s_mov_b32 exec_lo, 0xffffffff
    s_mov_b32 exec_hi, 0
GF_14:
    buffer_load_dword v1, v8, s[60:63], 0 offen sc1
    s_waitcnt vmcnt(0)
    v_cmp_eq_u32 vcc, 0, v1
    s_cmp_eq_u64 vcc, 0
    s_cbranch_scc1 GD_15
    s_sleep 8
    s_sub_u32 s14, s14, 1
    s_cbranch_scc1 L_END
    s_branch GF_14
GD_15:
    s_mov_b64 exec, -1
    s_lshl_b32 s17, s4, 12
    s_add_u32 s17, s17, 1179648
    v_lshlrev_b32 v8, 7, v0
    s_mov_b32 exec_lo, 0xfffff
    s_mov_b32 exec_hi, 0
    s_mov_b32 s18, 40
HG_16:
    buffer_load_dword v1, v8, s[64:67], s17 offen sc1
    s_waitcnt vmcnt(0)
    v_cmp_ne_u32 vcc, -1, v1
    s_cmp_lg_u64 vcc, 0
    s_cbranch_scc1 HG_13
    s_sleep 4
    s_sub_u32 s18, s18, 1
    s_cbranch_scc0 HG_16
HG_13:
    s_mov_b64 exec, -1
    v_mov_b32 v1, 1
    ds_write_b32 v2, v1 offset:0
HG_12:
W_17:
    ds_read_b32 v1, v2 offset:0
    s_waitcnt lgkmcnt(0)
    v_readfirstlane_b32 s16, v1
    s_cmp_ge_u32 s16, 1
    s_cbranch_scc1 WD_18
    s_sleep 1
    s_sub_u32 s14, s14, 1
    s_cbranch_scc1 L_END
    s_branch W_17
WD_18:
    buffer_load_dword v104, v24, s[64:67], s70 offen sc1
    buffer_load_dword v105, v25, s[64:67], s70 offen sc1
    buffer_load_dword v106, v26, s[64:67], s70 offen sc1
    buffer_load_dword v107, v27, s[64:67], s70 offen sc1
    buffer_load_dword v108, v28, s[64:67], s70 offen sc1
    buffer_load_dword v109, v29, s[64:67], s70 offen sc1
    buffer_load_dword v110, v30, s[64:67], s70 offen sc1
    buffer_load_dword v111, v31, s[64:67], s70 offen sc1
    s_sleep 8
    buffer_load_dword v112, v24, s[64:67], s70 offen sc1
    buffer_load_dword v113, v25, s[64:67], s70 offen sc1
    buffer_load_dword v114, v26, s[64:67], s70 offen sc1
    buffer_load_dword v115, v27, s[64:67], s70 offen sc1
    buffer_load_dword v116, v28, s[64:67], s70 offen sc1
    buffer_load_dword v117, v29, s[64:67], s70 offen sc1
    buffer_load_dword v118, v30, s[64:67], s70 offen sc1
    buffer_load_dword v119, v31, s[64:67], s70 offen sc1
P_19:
    s_waitcnt vmcnt(8)
    v_add_f32 v12, v104, v105
    v_add_f32 v13, v106, v107
    v_add_f32 v14, v108, v109
    v_add_f32 v15, v110, v111
    v_add_f32 v12, v12, v13
    v_add_f32 v14, v14, v15
    v_add_f32 v8, v12, v14
    v_cmp_u_f32 vcc, v8, v8
    s_cmp_eq_u64 vcc, 0
    s_cbranch_scc1 PD_20
    v_max_u32 v1, v104, v105
    v_max3_u32 v1, v1, v106, v107
    v_max3_u32 v1, v1, v108, v109
    v_max3_u32 v1, v1, v110, v111
    v_cmp_eq_u32 vcc, -1, v1
    s_cmp_eq_u64 vcc, 0
    s_cbranch_scc1 PD_20
    s_sub_u32 s14, s14, 1
    s_cbranch_scc1 L_END
    buffer_load_dword v104, v24, s[64:67], s70 offen sc1
    buffer_load_dword v105, v25, s[64:67], s70 offen sc1
    buffer_load_dword v106, v26, s[64:67], s70 offen sc1
    buffer_load_dword v107, v27, s[64:67], s70 offen sc1
    buffer_load_dword v108, v28, s[64:67], s70 offen sc1
    buffer_load_dword v109, v29, s[64:67], s70 offen sc1
    buffer_load_dword v110, v30, s[64:67], s70 offen sc1
    buffer_load_dword v111, v31, s[64:67], s70 offen sc1
    s_waitcnt vmcnt(8)
    v_add_f32 v12, v112, v113
    v_add_f32 v13, v114, v115
    v_add_f32 v14, v116, v117
    v_add_f32 v15, v118, v119
    v_add_f32 v12, v12, v13
    v_add_f32 v14, v14, v15
    v_add_f32 v8, v12, v14
    v_cmp_u_f32 vcc, v8, v8
    s_cmp_eq_u64 vcc, 0
    s_cbranch_scc1 PD_20
    v_max_u32 v1, v112, v113
    v_max3_u32 v1, v1, v114, v115
    v_max3_u32 v1, v1, v116, v117
    v_max3_u32 v1, v1, v118, v119
    v_cmp_eq_u32 vcc, -1, v1
    s_cmp_eq_u64 vcc, 0
    s_cbranch_scc1 PD_20
    s_sub_u32 s14, s14, 1
    s_cbranch_scc1 L_END
    buffer_load_dword v112, v24, s[64:67], s70 offen sc1
    buffer_load_dword v113, v25, s[64:67], s70 offen sc1
    buffer_load_dword v114, v26, s[64:67], s70 offen sc1
    buffer_load_dword v115, v27, s[64:67], s70 offen sc1
    buffer_load_dword v116, v28, s[64:67], s70 offen sc1
    buffer_load_dword v117, v29, s[64:67], s70 offen sc1
    buffer_load_dword v118, v30, s[64:67], s70 offen sc1
    buffer_load_dword v119, v31, s[64:67], s70 offen sc1
    s_branch P_19
PD_20:
    v_cvt_pk_bf16_f32 v8, v8, v8
    v_lshlrev_b32 v8, 16, v8
    v_add_f32 v8, v8, v20
    v_cvt_pk_bf16_f32 v21, v8, v8
    v_lshlrev_b32 v21, 16, v21
    ds_write_b32 v32, v21
    v_readfirstlane_b32 s17, v21
    s_nop 1
    v_subrev_f32 v8, s17, v21
    v_mul_f32 v9, v8, v8
    s_nop 0
    v_add_f32_dpp v8, v8, v8 quad_perm:[1,0,3,2] row_mask:0xf bank_mask:0xf
    v_add_f32_dpp v9, v9, v9 quad_perm:[1,0,3,2] row_mask:0xf bank_mask:0xf
    s_nop 0
    v_add_f32_dpp v8, v8, v8 quad_perm:[2,3,0,1] row_mask:0xf bank_mask:0xf
    v_add_f32_dpp v9, v9, v9 quad_perm:[2,3,0,1] row_mask:0xf bank_mask:0xf
    s_nop 0
    v_add_f32_dpp v8, v8, v8 row_half_mirror row_mask:0xf bank_mask:0xf
    v_add_f32_dpp v9, v9, v9 row_half_mirror row_mask:0xf bank_mask:0xf
    s_nop 0
    v_add_f32_dpp v8, v8, v8 row_ror:8 row_mask:0xf bank_mask:0xf
    v_add_f32_dpp v9, v9, v9 row_ror:8 row_mask:0xf bank_mask:0xf
    s_nop 0
    v_add_f32_dpp v8, v8, v8 row_bcast:15 row_mask:0xa bank_mask:0xf
    v_add_f32_dpp v9, v9, v9 row_bcast:15 row_mask:0xa bank_mask:0xf
    s_nop 0
    v_add_f32_dpp v8, v8, v8 row_bcast:31 row_mask:0xc bank_mask:0xf
    v_add_f32_dpp v9, v9, v9 row_bcast:31 row_mask:0xc bank_mask:0xf
    s_nop 0
    v_readlane_b32 s18, v8, 63
    v_readlane_b32 s19, v9, 63
    s_nop 1
    v_mov_b32 v8, 0x3c800000
    v_mul_f32 v8, s18, v8
    v_mov_b32 v9, s19
    v_fma_f32 v11, -v8, s18, v9
    v_add_f32 v10, s17, v8
    ds_write_b64 v33, v[10:11]
    s_waitcnt lgkmcnt(0)
    s_barrier
    ds_read_b64 v[10:11], v34
    s_waitcnt lgkmcnt(0)
    v_add_f32_dpp v8, v10, v10 row_ror:1 row_mask:0xf bank_mask:0xf
    s_nop 1
    v_add_f32_dpp v8, v8, v8 row_ror:2 row_mask:0xf bank_mask:0xf
    s_nop 1
    v_add_f32_dpp v8, v8, v8 row_ror:4 row_mask:0xf bank_mask:0xf
    s_nop 1
    v_add_f32_dpp v8, v8, v8 row_ror:8 row_mask:0xf bank_mask:0xf
    v_mul_f32 v8, 0x3dcccccd, v8
    v_sub_f32 v10, v10, v8
    v_cvt_pk_bf16_f32 v12, v8, v8
    v_mul_f32 v10, v10, v10
    v_lshlrev_b32 v12, 16, v12
    v_fmac_f32 v11, v10, v5
    v_sub_f32 v12, v21, v12
    v_cvt_pk_bf16_f32 v12, v12, v12
    v_add_f32_dpp v9, v11, v11 row_ror:1 row_mask:0xf bank_mask:0xf
    v_lshlrev_b32 v10, 16, v12
    s_nop 0
    v_add_f32_dpp v9, v9, v9 row_ror:2 row_mask:0xf bank_mask:0xf
    s_nop 1
    v_add_f32_dpp v9, v9, v9 row_ror:4 row_mask:0xf bank_mask:0xf
    s_nop 1
    v_add_f32_dpp v9, v9, v9 row_ror:8 row_mask:0xf bank_mask:0xf
    v_mul_f32 v9, 0x3acccccd, v9
    v_cvt_pk_bf16_f32 v9, v9, v9
    v_lshlrev_b32 v9, 16, v9
    v_add_f32 v9, 0x3727c5ac, v9
    v_cvt_pk_bf16_f32 v9, v9, v9
    v_lshlrev_b32 v9, 16, v9
    v_sqrt_f32 v9, v9
    s_nop 0
    v_cvt_pk_bf16_f32 v9, v9, v9
    v_lshlrev_b32 v9, 16, v9
    v_rcp_f32 v11, v9
    s_nop 0
    v_mul_f32 v8, v10, v11
    v_fma_f32 v12, -v8, v9, v10
    v_fma_f32 v8, v12, v11, v8
    v_cvt_pk_bf16_f32 v8, v8, v8
    ds_write_b16 v35, v8
    ds_read_b128 v[136:139], v37 offset:0
    ds_read_b128 v[140:143], v37 offset:16
    ds_read_b128 v[144:147], v37 offset:32
    ds_read_b128 v[148:151], v37 offset:48
    ds_read_b128 v[152:155], v37 offset:64
    ds_read_b128 v[156:159], v37 offset:80
    ds_read_b128 v[160:163], v37 offset:96
    ds_read_b128 v[164:167], v37 offset:112
    s_waitcnt lgkmcnt(7)
    v_mfma_f32_16x16x32_bf16 v[24:27], v[136:139], v[40:43], 0
    v_mfma_f32_16x16x32_bf16 v[28:31], v[136:139], v[72:75], 0
    s_waitcnt lgkmcnt(6)
    v_mfma_f32_16x16x32_bf16 v[24:27], v[140:143], v[44:47], v[24:27]
    v_mfma_f32_16x16x32_bf16 v[28:31], v[140:143], v[76:79], v[28:31]
    s_waitcnt lgkmcnt(5)
    v_mfma_f32_16x16x32_bf16 v[24:27], v[144:147], v[48:51], v[24:27]
    v_mfma_f32_16x16x32_bf16 v[28:31], v[144:147], v[80:83], v[28:31]
    s_waitcnt lgkmcnt(4)
    v_mfma_f32_16x16x32_bf16 v[24:27], v[148:151], v[52:55], v[24:27]
    v_mfma_f32_16x16x32_bf16 v[28:31], v[148:151], v[84:87], v[28:31]
    s_waitcnt lgkmcnt(3)
    v_mfma_f32_16x16x32_bf16 v[24:27], v[152:155], v[56:59], v[24:27]
    v_mfma_f32_16x16x32_bf16 v[28:31], v[152:155], v[88:91], v[28:31]
    s_waitcnt lgkmcnt(2)
    v_mfma_f32_16x16x32_bf16 v[24:27], v[156:159], v[60:63], v[24:27]
    v_mfma_f32_16x16x32_bf16 v[28:31], v[156:159], v[92:95], v[28:31]
    s_waitcnt lgkmcnt(1)
    v_mfma_f32_16x16x32_bf16 v[24:27], v[160:163], v[64:67], v[24:27]
    v_mfma_f32_16x16x32_bf16 v[28:31], v[160:163], v[96:99], v[28:31]
    s_waitcnt lgkmcnt(0)
    v_mfma_f32_16x16x32_bf16 v[24:27], v[164:167], v[68:71], v[24:27]
    v_mfma_f32_16x16x32_bf16 v[28:31], v[164:167], v[100:103], v[28:31]
    ds_read_b64_tr_b16 v[40:41], v7 offset:0
    ds_read_b64_tr_b16 v[42:43], v7 offset:512
    ds_read_b64_tr_b16 v[44:45], v7 offset:1024
    ds_read_b64_tr_b16 v[46:47], v7 offset:1536
    ds_read_b64_tr_b16 v[48:49], v7 offset:2048
    ds_read_b64_tr_b16 v[50:51], v7 offset:2560
    ds_read_b64_tr_b16 v[52:53], v7 offset:3072
    ds_read_b64_tr_b16 v[54:55], v7 offset:3584
    s_mov_b32 exec_lo, 0xffff
    s_mov_b32 exec_hi, 0
    ds_write2_b32 v38, v24, v25 offset0:0 offset1:16
    ds_write2_b32 v38, v26, v27 offset0:32 offset1:48
    ds_write2_b32 v38, v28, v29 offset0:64 offset1:80
    ds_write2_b32 v38, v30, v31 offset0:96 offset1:112
    s_mov_b64 exec, -1
    s_waitcnt lgkmcnt(0)
    s_barrier
    ds_read2st64_b32 v[136:137], v22 offset0:0 offset1:1
    ds_read2st64_b32 v[138:139], v22 offset0:2 offset1:3
    ds_read2st64_b32 v[140:141], v22 offset0:4 offset1:5
    ds_read2st64_b32 v[142:143], v22 offset0:6 offset1:7
    ds_read2st64_b32 v[144:145], v22 offset0:8 offset1:9
    ds_read2st64_b32 v[146:147], v22 offset0:10 offset1:11
    ds_read2st64_b32 v[148:149], v22 offset0:12 offset1:13
    ds_read2st64_b32 v[150:151], v22 offset0:14 offset1:15
    ds_read2st64_b32 v[152:153], v22 offset0:16 offset1:17
    ds_read2st64_b32 v[154:155], v22 offset0:18 offset1:19
    s_waitcnt lgkmcnt(0)
    ds_read_b64_tr_b16 v[56:57], v7 offset:4096
    ds_read_b64_tr_b16 v[58:59], v7 offset:4608
    ds_read_b64_tr_b16 v[60:61], v7 offset:5120
    ds_read_b64_tr_b16 v[62:63], v7 offset:5632
    ds_read_b64_tr_b16 v[64:65], v7 offset:6144
    ds_read_b64_tr_b16 v[66:67], v7 offset:6656
    ds_read_b64_tr_b16 v[68:69], v7 offset:7168
    ds_read_b64_tr_b16 v[70:71], v7 offset:7680
    v_pk_add_f32 v[136:137], v[136:137], v[138:139]
    v_pk_add_f32 v[140:141], v[140:141], v[142:143]
    v_pk_add_f32 v[144:145], v[144:145], v[146:147]
    v_pk_add_f32 v[148:149], v[148:149], v[150:151]
    v_pk_add_f32 v[152:153], v[152:153], v[154:155]
    v_pk_add_f32 v[136:137], v[136:137], v[140:141]
    v_pk_add_f32 v[144:145], v[144:145], v[148:149]
    v_pk_add_f32 v[136:137], v[136:137], v[144:145]
    v_pk_add_f32 v[136:137], v[136:137], v[152:153]
    v_cvt_pk_bf16_f32 v12, v136, v137
    v_and_b32 v13, 0xffff0000, v12
    v_lshlrev_b32 v12, 16, v12
    v_mul_f32 v12, 0xbfb8aa3b, v12
    v_exp_f32 v12, v12
    s_nop 0
    v_add_f32 v12, 1.0, v12
    v_rcp_f32 v14, v12
    s_nop 0
    v_cvt_pk_bf16_f32 v14, v14, v14
    v_lshlrev_b32 v14, 16, v14
    v_mul_f32 v14, v14, v13
    v_cvt_pk_bf16_f32 v14, v14, v14
    ds_write_b16 v35, v14 offset:1280
    ds_read_b128 v[136:139], v36 offset:0
    ds_read_b128 v[140:143], v36 offset:16
    ds_read_b128 v[144:147], v36 offset:32
    ds_read_b128 v[148:151], v36 offset:48
    ds_read_b128 v[152:155], v36 offset:64
    ds_read_b128 v[156:159], v36 offset:80
    ds_read_b128 v[160:163], v36 offset:96
    ds_read_b128 v[164:167], v36 offset:112
    s_waitcnt lgkmcnt(7)
    v_mfma_f32_16x16x32_bf16 v[24:27], v[136:139], v[40:43], 0
    s_waitcnt lgkmcnt(6)
    v_mfma_f32_16x16x32_bf16 v[24:27], v[140:143], v[44:47], v[24:27]
    s_waitcnt lgkmcnt(5)
    v_mfma_f32_16x16x32_bf16 v[24:27], v[144:147], v[48:51], v[24:27]
    s_waitcnt lgkmcnt(4)
    v_mfma_f32_16x16x32_bf16 v[24:27], v[148:151], v[52:55], v[24:27]
    s_waitcnt lgkmcnt(3)
    v_mfma_f32_16x16x32_bf16 v[24:27], v[152:155], v[56:59], v[24:27]
    s_waitcnt lgkmcnt(2)
    v_mfma_f32_16x16x32_bf16 v[24:27], v[156:159], v[60:63], v[24:27]
    s_waitcnt lgkmcnt(1)
    v_mfma_f32_16x16x32_bf16 v[24:27], v[160:163], v[64:67], v[24:27]
    s_waitcnt lgkmcnt(0)
    v_mfma_f32_16x16x32_bf16 v[24:27], v[164:167], v[68:71], v[24:27]
    s_nop 7
    v_min_u32 v24, -2, v24
    v_min_u32 v25, -2, v25
    v_min_u32 v26, -2, v26
    v_min_u32 v27, -2, v27
    s_mov_b32 exec_lo, 0xffff
    s_mov_b32 exec_hi, 0
    buffer_store_dwordx4 v[24:27], v39, s[64:67], s21 offen sc1
    s_mov_b64 exec, -1
    s_cmp_lg_u32 s3, 0
    s_cbranch_scc1 L_END
    s_cmp_ge_u32 s20, 20
    s_cbranch_scc1 L_END
    v_lshrrev_b32 v5, 5, v0
    v_mul_u32_u24 v5, 30720, v5
    v_and_b32 v8, 31, v0
    v_lshl_add_u32 v5, v8, 2, v5
    s_and_b32 s18, s20, 1
    s_lshl_b32 s18, s18, 5
    v_add_u32 v8, s18, v8
    v_lshrrev_b32 v9, 2, v8
    v_and_b32 v8, 3, v8
    v_lshl_add_u32 v8, v8, 4, v9
    s_lshr_b32 s18, s20, 1
    s_lshl_b32 s18, s18, 6
    v_add_u32 v8, s18, v8
    v_lshlrev_b32 v6, 1, v8
    v_lshlrev_b32 v9, 2, v8
    v_add_u32 v9, 143360, v9
    ds_read_b32 v21, v9
    s_lshl_b32 s17, s20, 7
    s_add_u32 s96, s17, 1245184
    s_add_u32 s97, s17, 1250304
    s_add_u32 s98, s17, 1255424
    s_add_u32 s99, s17, 1260544
    s_add_u32 s100, s17, 1265664
    s_add_u32 s101, s17, 1270784
    buffer_load_dword v40, v5, s[64:67], s96 offen offset:0 sc1
    buffer_load_dword v41, v5, s[64:67], s96 offen offset:2560 sc1
    buffer_load_dword v42, v5, s[64:67], s97 offen offset:0 sc1
    buffer_load_dword v43, v5, s[64:67], s97 offen offset:2560 sc1
    buffer_load_dword v44, v5, s[64:67], s98 offen offset:0 sc1
    buffer_load_dword v45, v5, s[64:67], s98 offen offset:2560 sc1
    buffer_load_dword v46, v5, s[64:67], s99 offen offset:0 sc1
    buffer_load_dword v47, v5, s[64:67], s99 offen offset:2560 sc1
    buffer_load_dword v48, v5, s[64:67], s100 offen offset:0 sc1
    buffer_load_dword v49, v5, s[64:67], s100 offen offset:2560 sc1
    buffer_load_dword v50, v5, s[64:67], s101 offen offset:0 sc1
    buffer_load_dword v51, v5, s[64:67], s101 offen offset:2560 sc1
    s_sleep 8
    buffer_load_dword v52, v5, s[64:67], s96 offen offset:0 sc1
    buffer_load_dword v53, v5, s[64:67], s96 offen offset:2560 sc1
    buffer_load_dword v54, v5, s[64:67], s97 offen offset:0 sc1
    buffer_load_dword v55, v5, s[64:67], s97 offen offset:2560 sc1
    buffer_load_dword v56, v5, s[64:67], s98 offen offset:0 sc1
    buffer_load_dword v57, v5, s[64:67], s98 offen offset:2560 sc1
    buffer_load_dword v58, v5, s[64:67], s99 offen offset:0 sc1
    buffer_load_dword v59, v5, s[64:67], s99 offen offset:2560 sc1
    buffer_load_dword v60, v5, s[64:67], s100 offen offset:0 sc1
    buffer_load_dword v61, v5, s[64:67], s100 offen offset:2560 sc1
    buffer_load_dword v62, v5, s[64:67], s101 offen offset:0 sc1
    buffer_load_dword v63, v5, s[64:67], s101 offen offset:2560 sc1
P_21:
    s_waitcnt vmcnt(12)
    v_add_f32 v12, v40, v41
    v_add_f32 v13, v42, v43
    v_add_f32 v14, v44, v45
    v_add_f32 v15, v46, v47
    v_add_f32 v16, v48, v49
    v_add_f32 v17, v50, v51
    v_add_f32 v12, v12, v13
    v_add_f32 v14, v14, v15
    v_add_f32 v16, v16, v17
    v_add_f32 v12, v12, v14
    v_add_f32 v8, v12, v16
    v_cmp_u_f32 vcc, v8, v8
    s_cmp_eq_u64 vcc, 0
    s_cbranch_scc1 PD_22
    v_max_u32 v1, v40, v41
    v_max3_u32 v1, v1, v42, v43
    v_max3_u32 v1, v1, v44, v45
    v_max3_u32 v1, v1, v46, v47
    v_max3_u32 v1, v1, v48, v49
    v_max3_u32 v1, v1, v50, v51
    v_cmp_eq_u32 vcc, -1, v1
    s_cmp_eq_u64 vcc, 0
    s_cbranch_scc1 PD_22
    s_sub_u32 s14, s14, 1
    s_cbranch_scc1 L_END
    buffer_load_dword v40, v5, s[64:67], s96 offen offset:0 sc1
    buffer_load_dword v41, v5, s[64:67], s96 offen offset:2560 sc1
    buffer_load_dword v42, v5, s[64:67], s97 offen offset:0 sc1
    buffer_load_dword v43, v5, s[64:67], s97 offen offset:2560 sc1
    buffer_load_dword v44, v5, s[64:67], s98 offen offset:0 sc1
    buffer_load_dword v45, v5, s[64:67], s98 offen offset:2560 sc1
    buffer_load_dword v46, v5, s[64:67], s99 offen offset:0 sc1
    buffer_load_dword v47, v5, s[64:67], s99 offen offset:2560 sc1
    buffer_load_dword v48, v5, s[64:67], s100 offen offset:0 sc1
    buffer_load_dword v49, v5, s[64:67], s100 offen offset:2560 sc1
    buffer_load_dword v50, v5, s[64:67], s101 offen offset:0 sc1
    buffer_load_dword v51, v5, s[64:67], s101 offen offset:2560 sc1
    s_waitcnt vmcnt(12)
    v_add_f32 v12, v52, v53
    v_add_f32 v13, v54, v55
    v_add_f32 v14, v56, v57
    v_add_f32 v15, v58, v59
    v_add_f32 v16, v60, v61
    v_add_f32 v17, v62, v63
    v_add_f32 v12, v12, v13
    v_add_f32 v14, v14, v15
    v_add_f32 v16, v16, v17
    v_add_f32 v12, v12, v14
    v_add_f32 v8, v12, v16
    v_cmp_u_f32 vcc, v8, v8
    s_cmp_eq_u64 vcc, 0
    s_cbranch_scc1 PD_22
    v_max_u32 v1, v52, v53
    v_max3_u32 v1, v1, v54, v55
    v_max3_u32 v1, v1, v56, v57
    v_max3_u32 v1, v1, v58, v59
    v_max3_u32 v1, v1, v60, v61
    v_max3_u32 v1, v1, v62, v63
    v_cmp_eq_u32 vcc, -1, v1
    s_cmp_eq_u64 vcc, 0
    s_cbranch_scc1 PD_22
    s_sub_u32 s14, s14, 1
    s_cbranch_scc1 L_END
    buffer_load_dword v52, v5, s[64:67], s96 offen offset:0 sc1
    buffer_load_dword v53, v5, s[64:67], s96 offen offset:2560 sc1
    buffer_load_dword v54, v5, s[64:67], s97 offen offset:0 sc1
    buffer_load_dword v55, v5, s[64:67], s97 offen offset:2560 sc1
    buffer_load_dword v56, v5, s[64:67], s98 offen offset:0 sc1
    buffer_load_dword v57, v5, s[64:67], s98 offen offset:2560 sc1
    buffer_load_dword v58, v5, s[64:67], s99 offen offset:0 sc1
    buffer_load_dword v59, v5, s[64:67], s99 offen offset:2560 sc1
    buffer_load_dword v60, v5, s[64:67], s100 offen offset:0 sc1
    buffer_load_dword v61, v5, s[64:67], s100 offen offset:2560 sc1
    buffer_load_dword v62, v5, s[64:67], s101 offen offset:0 sc1
    buffer_load_dword v63, v5, s[64:67], s101 offen offset:2560 sc1
    s_branch P_21
PD_22:
    v_mov_b32 v9, v8
    s_nop 1
    v_permlane32_swap_b32 v8, v9
    s_nop 1
    v_add_f32 v8, v8, v9
    v_cvt_pk_bf16_f32 v8, v8, v8
    v_lshlrev_b32 v8, 16, v8
    s_waitcnt lgkmcnt(0)
    v_add_f32 v8, v8, v21
    v_cvt_pk_bf16_f32 v8, v8, v8
    s_mov_b32 exec_lo, 0xffffffff
    s_mov_b32 exec_hi, 0
    buffer_store_short v8, v6, s[56:59], 0 offen
    s_mov_b64 exec, -1
    s_branch L_END
L_COMPUTE:
    s_waitcnt vmcnt(3)
    buffer_load_dwordx4 v[52:55], v3, s[28:31], s21 offen offset:0 nt
    s_waitcnt vmcnt(3)
    buffer_load_dwordx4 v[56:59], v3, s[28:31], s21 offen offset:128 nt
    s_waitcnt vmcnt(3)
    buffer_load_dwordx4 v[60:63], v3, s[28:31], s21 offen offset:256 nt
    s_add_u32 s21, s21, 24576
    s_waitcnt vmcnt(3)
    buffer_load_dwordx4 v[64:67], v3, s[28:31], s21 offen offset:0 nt
    s_waitcnt vmcnt(3)
    buffer_load_dwordx4 v[68:71], v3, s[28:31], s21 offen offset:128 nt
    s_waitcnt vmcnt(3)
    buffer_load_dwordx4 v[72:75], v3, s[28:31], s21 offen offset:256 nt
    s_add_u32 s21, s21, 24576
    s_waitcnt vmcnt(3)
    buffer_load_dwordx4 v[76:79], v3, s[28:31], s21 offen offset:0 nt
    s_waitcnt vmcnt(3)
    buffer_load_dwordx4 v[80:83], v3, s[28:31], s21 offen offset:128 nt
    s_waitcnt vmcnt(3)
    buffer_load_dwordx4 v[84:87], v3, s[28:31], s21 offen offset:256 nt
    s_add_u32 s21, s21, 24576
    s_cmp_eq_u32 s23, 0
    s_cbranch_scc1 K5_23
    s_waitcnt vmcnt(3)
    buffer_load_dwordx4 v[88:91], v3, s[28:31], s21 offen offset:0 nt
    s_waitcnt vmcnt(3)
    buffer_load_dwordx4 v[92:95], v3, s[28:31], s21 offen offset:128 nt
    s_waitcnt vmcnt(3)
    buffer_load_dwordx4 v[96:99], v3, s[28:31], s21 offen offset:256 nt
    s_add_u32 s21, s21, 24576
K5_23:
    v_mov_b32 v1, 1
    s_mov_b64 exec, 1
    ds_add_u32 v2, v1 offset:4
    s_mov_b64 exec, -1
    v_lshrrev_b32 v120, 5, v0
    v_lshlrev_b32 v120, 8, v120
    v_bfe_u32 v121, v0, 2, 2
    v_lshl_add_u32 v120, v121, 6, v120
    v_bfe_u32 v121, v0, 4, 1
    v_lshl_add_u32 v120, v121, 5, v120
    v_and_b32 v121, 3, v0
    v_lshl_add_u32 v120, v121, 3, v120
    s_lshl_b32 s17, s3, 10
    s_add_u32 s17, s17, 116736
    v_add_u32 v120, s17, v120
    s_mul_i32 s95, s8, 3
    s_mul_i32 s19, s12, 10
    s_add_u32 s95, s95, s19
    s_mul_i32 s17, s4, 73728
    s_mul_i32 s18, s5, 2560
    s_add_u32 s17, s17, s18
    s_lshl_b32 s18, s3, 8
    s_add_u32 s17, s17, s18
    s_add_u32 s94, s17, 589824
    v_lshlrev_b32 v121, 2, v0
    v_mov_b32 v122, 160000
    v_and_b32 v4, 7, v0
    v_lshlrev_b32 v4, 4, v4
    v_add_u32 v4, 158976, v4
    v_mov_b32 v20, 0
    v_mov_b32 v21, 0
    v_mov_b32 v22, 0
    v_mov_b32 v23, 0
    v_mov_b32 v24, 0
    v_mov_b32 v30, 0
    v_mov_b32 v31, 0
    v_mov_b32 v32, 0
    v_mov_b32 v33, 0
    v_mov_b32 v34, 0
    v_mov_b32 v35, 0
    v_mov_b32 v36, 0
    v_mov_b32 v37, 0
    v_mov_b32 v38, 0
    v_mov_b32 v39, 0
W_24:
    ds_read_b32 v1, v2 offset:8
    s_waitcnt lgkmcnt(0)
    v_readfirstlane_b32 s16, v1
    s_cmp_ge_u32 s16, 1
    s_cbranch_scc1 WD_25
    s_sleep 1
    s_sub_u32 s14, s14, 1
    s_cbranch_scc1 L_END
    s_branch W_24
WD_25:
    s_sub_u32 s15, s16, 1
    ds_read_b128 v[8:11], v4 offset:0
    ds_read_b128 v[12:15], v4 offset:128
    ds_read_b128 v[16:19], v4 offset:256
    s_waitcnt lgkmcnt(0)
    s_cmp_eq_u32 s23, 0
    s_cbranch_scc1 Q4_26
    s_waitcnt vmcnt(12)
    v_dot2c_f32_bf16 v20, v40, v8
    v_dot2c_f32_bf16 v30, v44, v12
    v_dot2c_f32_bf16 v35, v48, v16
    v_dot2c_f32_bf16 v20, v41, v9
    v_dot2c_f32_bf16 v30, v45, v13
    v_dot2c_f32_bf16 v35, v49, v17
    v_dot2c_f32_bf16 v20, v42, v10
    v_dot2c_f32_bf16 v30, v46, v14
    v_dot2c_f32_bf16 v35, v50, v18
    v_dot2c_f32_bf16 v20, v43, v11
    v_dot2c_f32_bf16 v30, v47, v15
    v_dot2c_f32_bf16 v35, v51, v19
    s_waitcnt vmcnt(9)
    v_dot2c_f32_bf16 v21, v52, v8
    v_dot2c_f32_bf16 v31, v56, v12
    v_dot2c_f32_bf16 v36, v60, v16
    v_dot2c_f32_bf16 v21, v53, v9
    v_dot2c_f32_bf16 v31, v57, v13
    v_dot2c_f32_bf16 v36, v61, v17
    v_dot2c_f32_bf16 v21, v54, v10
    v_dot2c_f32_bf16 v31, v58, v14
    v_dot2c_f32_bf16 v36, v62, v18
    v_dot2c_f32_bf16 v21, v55, v11
    v_dot2c_f32_bf16 v31, v59, v15
    v_dot2c_f32_bf16 v36, v63, v19
    s_waitcnt vmcnt(6)
    v_dot2c_f32_bf16 v22, v64, v8
    v_dot2c_f32_bf16 v32, v68, v12
    v_dot2c_f32_bf16 v37, v72, v16
    v_dot2c_f32_bf16 v22, v65, v9
    v_dot2c_f32_bf16 v32, v69, v13
    v_dot2c_f32_bf16 v37, v73, v17
    v_dot2c_f32_bf16 v22, v66, v10
    v_dot2c_f32_bf16 v32, v70, v14
    v_dot2c_f32_bf16 v37, v74, v18
    v_dot2c_f32_bf16 v22, v67, v11
    v_dot2c_f32_bf16 v32, v71, v15
    v_dot2c_f32_bf16 v37, v75, v19
    s_waitcnt vmcnt(3)
    v_dot2c_f32_bf16 v23, v76, v8
    v_dot2c_f32_bf16 v33, v80, v12
    v_dot2c_f32_bf16 v38, v84, v16
    v_dot2c_f32_bf16 v23, v77, v9
    v_dot2c_f32_bf16 v33, v81, v13
    v_dot2c_f32_bf16 v38, v85, v17
    v_dot2c_f32_bf16 v23, v78, v10
    v_dot2c_f32_bf16 v33, v82, v14
    v_dot2c_f32_bf16 v38, v86, v18
    v_dot2c_f32_bf16 v23, v79, v11
    v_dot2c_f32_bf16 v33, v83, v15
    v_dot2c_f32_bf16 v38, v87, v19
    s_waitcnt vmcnt(0)
    v_dot2c_f32_bf16 v24, v88, v8
    v_dot2c_f32_bf16 v34, v92, v12
    v_dot2c_f32_bf16 v39, v96, v16
    v_dot2c_f32_bf16 v24, v89, v9
    v_dot2c_f32_bf16 v34, v93, v13
    v_dot2c_f32_bf16 v39, v97, v17
    v_dot2c_f32_bf16 v24, v90, v10
    v_dot2c_f32_bf16 v34, v94, v14
    v_dot2c_f32_bf16 v39, v98, v18
    v_dot2c_f32_bf16 v24, v91, v11
    v_dot2c_f32_bf16 v34, v95, v15
    v_dot2c_f32_bf16 v39, v99, v19
    s_branch QD_27
Q4_26:
    s_waitcnt vmcnt(9)
    v_dot2c_f32_bf16 v20, v40, v8
    v_dot2c_f32_bf16 v30, v44, v12
    v_dot2c_f32_bf16 v35, v48, v16
    v_dot2c_f32_bf16 v20, v41, v9
    v_dot2c_f32_bf16 v30, v45, v13
    v_dot2c_f32_bf16 v35, v49, v17
    v_dot2c_f32_bf16 v20, v42, v10
    v_dot2c_f32_bf16 v30, v46, v14
    v_dot2c_f32_bf16 v35, v50, v18
    v_dot2c_f32_bf16 v20, v43, v11
    v_dot2c_f32_bf16 v30, v47, v15
    v_dot2c_f32_bf16 v35, v51, v19
    s_waitcnt vmcnt(6)
    v_dot2c_f32_bf16 v21, v52, v8
    v_dot2c_f32_bf16 v31, v56, v12
    v_dot2c_f32_bf16 v36, v60, v16
    v_dot2c_f32_bf16 v21, v53, v9
    v_dot2c_f32_bf16 v31, v57, v13
    v_dot2c_f32_bf16 v36, v61, v17
    v_dot2c_f32_bf16 v21, v54, v10
    v_dot2c_f32_bf16 v31, v58, v14
    v_dot2c_f32_bf16 v36, v62, v18
    v_dot2c_f32_bf16 v21, v55, v11
    v_dot2c_f32_bf16 v31, v59, v15
    v_dot2c_f32_bf16 v36, v63, v19
    s_waitcnt vmcnt(3)
    v_dot2c_f32_bf16 v22, v64, v8
    v_dot2c_f32_bf16 v32, v68, v12
    v_dot2c_f32_bf16 v37, v72, v16
    v_dot2c_f32_bf16 v22, v65, v9
    v_dot2c_f32_bf16 v32, v69, v13
    v_dot2c_f32_bf16 v37, v73, v17
    v_dot2c_f32_bf16 v22, v66, v10
    v_dot2c_f32_bf16 v32, v70, v14
    v_dot2c_f32_bf16 v37, v74, v18
    v_dot2c_f32_bf16 v22, v67, v11
    v_dot2c_f32_bf16 v32, v71, v15
    v_dot2c_f32_bf16 v37, v75, v19
    s_waitcnt vmcnt(0)
    v_dot2c_f32_bf16 v23, v76, v8
    v_dot2c_f32_bf16 v33, v80, v12
    v_dot2c_f32_bf16 v38, v84, v16
    v_dot2c_f32_bf16 v23, v77, v9
    v_dot2c_f32_bf16 v33, v81, v13
    v_dot2c_f32_bf16 v38, v85, v17
    v_dot2c_f32_bf16 v23, v78, v10
    v_dot2c_f32_bf16 v33, v82, v14
    v_dot2c_f32_bf16 v38, v86, v18
    v_dot2c_f32_bf16 v23, v79, v11
    v_dot2c_f32_bf16 v33, v83, v15
    v_dot2c_f32_bf16 v38, v87, v19
QD_27:
    s_nop 2
    v_add_f32 v20, v20, v30
    v_add_f32 v21, v21, v31
    v_add_f32 v22, v22, v32
    v_add_f32 v23, v23, v33
    v_add_f32 v24, v24, v34
    v_add_f32 v20, v20, v35
    v_add_f32 v21, v21, v36
    v_add_f32 v22, v22, v37
    v_add_f32 v23, v23, v38
    v_add_f32 v24, v24, v39
    v_add_f32_dpp v20, v20, v20 quad_perm:[1,0,3,2] row_mask:0xf bank_mask:0xf
    v_add_f32_dpp v21, v21, v21 quad_perm:[1,0,3,2] row_mask:0xf bank_mask:0xf
    v_add_f32_dpp v22, v22, v22 quad_perm:[1,0,3,2] row_mask:0xf bank_mask:0xf
    v_add_f32_dpp v23, v23, v23 quad_perm:[1,0,3,2] row_mask:0xf bank_mask:0xf
    v_add_f32_dpp v24, v24, v24 quad_perm:[1,0,3,2] row_mask:0xf bank_mask:0xf
    v_add_f32_dpp v20, v20, v20 quad_perm:[2,3,0,1] row_mask:0xf bank_mask:0xf
    v_add_f32_dpp v21, v21, v21 quad_perm:[2,3,0,1] row_mask:0xf bank_mask:0xf
    v_add_f32_dpp v22, v22, v22 quad_perm:[2,3,0,1] row_mask:0xf bank_mask:0xf
    v_add_f32_dpp v23, v23, v23 quad_perm:[2,3,0,1] row_mask:0xf bank_mask:0xf
    v_add_f32_dpp v24, v24, v24 quad_perm:[2,3,0,1] row_mask:0xf bank_mask:0xf
    v_add_f32_dpp v20, v20, v20 row_half_mirror row_mask:0xf bank_mask:0xf
    v_add_f32_dpp v21, v21, v21 row_half_mirror row_mask:0xf bank_mask:0xf
    v_add_f32_dpp v22, v22, v22 row_half_mirror row_mask:0xf bank_mask:0xf
    v_add_f32_dpp v23, v23, v23 row_half_mirror row_mask:0xf bank_mask:0xf
    v_add_f32_dpp v24, v24, v24 row_half_mirror row_mask:0xf bank_mask:0xf
    s_mov_b32 s17, 0x3d93cd3a
    v_cvt_pk_bf16_f32 v20, v20, v20
    v_cvt_pk_bf16_f32 v21, v21, v21
    v_cvt_pk_bf16_f32 v22, v22, v22
    v_cvt_pk_bf16_f32 v23, v23, v23
    v_cvt_pk_bf16_f32 v24, v24, v24
    v_lshlrev_b32 v20, 16, v20
    v_lshlrev_b32 v21, 16, v21
    v_lshlrev_b32 v22, 16, v22
    v_lshlrev_b32 v23, 16, v23
    v_lshlrev_b32 v24, 16, v24
    v_mul_f32 v20, s17, v20
    v_mul_f32 v21, s17, v21
    v_mul_f32 v22, s17, v22
    v_mul_f32 v23, s17, v23
    v_mul_f32 v24, s17, v24
    v_cvt_pk_bf16_f32 v20, v20, v20
    v_cvt_pk_bf16_f32 v21, v21, v21
    v_cvt_pk_bf16_f32 v22, v22, v22
    v_cvt_pk_bf16_f32 v23, v23, v23
    v_cvt_pk_bf16_f32 v24, v24, v24
    v_lshlrev_b32 v20, 16, v20
    v_lshlrev_b32 v21, 16, v21
    v_lshlrev_b32 v22, 16, v22
    v_lshlrev_b32 v23, 16, v23
    v_lshlrev_b32 v24, 16, v24
    s_cmp_lg_u32 s23, 0
    s_cbranch_scc1 S5_28
    v_mov_b32 v24, 0xff800000
S5_28:
    v_max3_f32 v5, v20, v21, v22
    v_max3_f32 v5, v5, v23, v24
    s_nop 1
    v_max_f32_dpp v5, v5, v5 row_ror:8 row_mask:0xf bank_mask:0xf
    s_nop 1
    v_max_f32_dpp v5, v5, v5 row_bcast:15 row_mask:0xa bank_mask:0xf
    s_nop 1
    v_max_f32_dpp v5, v5, v5 row_bcast:31 row_mask:0xc bank_mask:0xf
    s_nop 0
    v_readlane_b32 s18, v5, 63
    s_nop 1
    s_mov_b32 s17, 0x3fb8aa3b
    v_subrev_f32 v8, s18, v20
    v_subrev_f32 v9, s18, v21
    v_subrev_f32 v10, s18, v22
    v_subrev_f32 v11, s18, v23
    v_subrev_f32 v12, s18, v24
    v_mul_f32 v8, s17, v8
    v_mul_f32 v9, s17, v9
    v_mul_f32 v10, s17, v10
    v_mul_f32 v11, s17, v11
    v_mul_f32 v12, s17, v12
    v_exp_f32 v8, v8
    v_exp_f32 v9, v9
    v_exp_f32 v10, v10
    v_exp_f32 v11, v11
    v_exp_f32 v12, v12
    s_nop 0
    v_add_f32 v8, v8, v9
    v_add_f32 v10, v10, v11
    v_add_f32 v8, v8, v10
    v_add_f32 v5, v8, v12
    s_nop 1
    v_add_f32_dpp v5, v5, v5 row_ror:8 row_mask:0xf bank_mask:0xf
    s_nop 1
    v_add_f32_dpp v5, v5, v5 row_bcast:15 row_mask:0xa bank_mask:0xf
    s_nop 1
    v_add_f32_dpp v5, v5, v5 row_bcast:31 row_mask:0xc bank_mask:0xf
    s_nop 0
    v_readlane_b32 s19, v5, 63
    s_nop 1
    v_mov_b32 v6, s18
    v_mov_b32 v7, s19
    v_min_u32 v6, -2, v6
    v_min_u32 v7, -2, v7
    s_lshl_b32 s17, s6, 10
    s_lshl_b32 s18, s7, 7
    s_add_u32 s17, s17, s18
    s_lshl_b32 s18, s20, 3
    s_add_u32 s17, s17, s18
    s_add_u32 s17, s17, 262144
    v_mov_b32 v4, 0
    s_mov_b64 exec, 1
    s_cmp_lg_u32 s15, 0
    s_cbranch_scc1 SF_29
    buffer_store_dwordx2 v[6:7], v4, s[64:67], s17 offen sc1
    s_branch SD_30
SF_29:
    buffer_store_dwordx2 v[6:7], v4, s[64:67], s17 offen
SD_30:
    s_mov_b64 exec, -1
    v_mov_b32 v1, 1
    s_mov_b64 exec, 1
    ds_add_u32 v2, v1 offset:40
    s_mov_b64 exec, -1
    v_lshrrev_b32 v3, 5, v0
    v_lshlrev_b32 v3, 8, v3
    v_bfe_u32 v4, v0, 2, 2
    v_lshl_add_u32 v3, v4, 6, v3
    v_bfe_u32 v4, v0, 4, 1
    v_lshl_add_u32 v3, v4, 5, v3
    v_and_b32 v4, 3, v0
    v_lshl_add_u32 v3, v4, 3, v3
    s_mul_i32 s17, s20, 3072
    v_add_u32 v3, s17, v3
    v_add_u32 v4, 73728, v3
    v_lshlrev_b32 v29, 4, v0
    v_add_u32 v25, s17, v29
    v_mul_u32_u24 v30, 12, v0
    s_lshl_b32 s68, s6, 13
    s_mul_i32 s18, s7, 768
    s_add_u32 s68, s68, s18
    s_add_u32 s68, s68, 327680
    v_lshrrev_b32 v5, 3, v0
    v_lshlrev_b32 v5, 1, v5
    s_lshl_b32 s17, s20, 4
    s_add_u32 s17, s17, 159360
    v_add_u32 v5, s17, v5
    v_mov_b32 v6, s17
    v_mov_b32 v26, 0
    v_mov_b32 v27, 0
    v_mov_b32 v28, 0
    s_add_u32 s21, s20, 1
    s_mul_i32 s21, s21, 3
    s_mov_b32 s22, 0
P1_39:
    ds_read_b64 v[8:9], v2 offset:24
    s_waitcnt lgkmcnt(0)
    v_readfirstlane_b32 s16, v8
    v_readfirstlane_b32 s17, v9
    s_cmp_lg_u32 s16, 0
    s_cbranch_scc1 PC_31
    s_cmp_ge_u32 s17, s21
    s_cbranch_scc1 P1_40
    s_sleep 1
    s_sub_u32 s14, s14, 1
    s_cbranch_scc1 L_END
    s_branch P1_39
P1_40:
    ds_read_b64_tr_b16 v[40:41], v3 offset:0
    ds_read_b64_tr_b16 v[42:43], v3 offset:512
    ds_read_b64_tr_b16 v[44:45], v3 offset:1024
    ds_read_b64_tr_b16 v[46:47], v3 offset:1536
    ds_read_b64_tr_b16 v[48:49], v3 offset:2048
    ds_read_b64_tr_b16 v[50:51], v3 offset:2560
    s_add_u32 s21, s21, 24
    s_mov_b32 s22, 1
P1_41:
    ds_read_b64 v[8:9], v2 offset:24
    s_waitcnt lgkmcnt(0)
    v_readfirstlane_b32 s16, v8
    v_readfirstlane_b32 s17, v9
    s_cmp_lg_u32 s16, 0
    s_cbranch_scc1 PC_31
    s_cmp_ge_u32 s17, s21
    s_cbranch_scc1 P1_42
    s_sleep 1
    s_sub_u32 s14, s14, 1
    s_cbranch_scc1 L_END
    s_branch P1_41
P1_42:
    ds_read_b64_tr_b16 v[52:53], v3 offset:24576
    ds_read_b64_tr_b16 v[54:55], v3 offset:25088
    ds_read_b64_tr_b16 v[56:57], v3 offset:25600
    ds_read_b64_tr_b16 v[58:59], v3 offset:26112
    ds_read_b64_tr_b16 v[60:61], v3 offset:26624
    ds_read_b64_tr_b16 v[62:63], v3 offset:27136
    s_add_u32 s21, s21, 24
    s_mov_b32 s22, 2
P1_43:
    ds_read_b64 v[8:9], v2 offset:24
    s_waitcnt lgkmcnt(0)
    v_readfirstlane_b32 s16, v8
    v_readfirstlane_b32 s17, v9
    s_cmp_lg_u32 s16, 0
    s_cbranch_scc1 PC_31
    s_cmp_ge_u32 s17, s21
    s_cbranch_scc1 P1_44
    s_sleep 1
    s_sub_u32 s14, s14, 1
    s_cbranch_scc1 L_END
    s_branch P1_43
P1_44:
    ds_read_b64_tr_b16 v[64:65], v3 offset:49152
    ds_read_b64_tr_b16 v[66:67], v3 offset:49664
    ds_read_b64_tr_b16 v[68:69], v3 offset:50176
    ds_read_b64_tr_b16 v[70:71], v3 offset:50688
    ds_read_b64_tr_b16 v[72:73], v3 offset:51200
    ds_read_b64_tr_b16 v[74:75], v3 offset:51712
    s_add_u32 s21, s21, 24
    s_mov_b32 s22, 3
P1_45:
    ds_read_b64 v[8:9], v2 offset:24
    s_waitcnt lgkmcnt(0)
    v_readfirstlane_b32 s16, v8
    v_readfirstlane_b32 s17, v9
    s_cmp_lg_u32 s16, 0
    s_cbranch_scc1 PC_31
    s_cmp_ge_u32 s17, s21
    s_cbranch_scc1 P1_46
    s_sub_u32 s14, s14, 1
    s_cbranch_scc1 L_END
    s_branch P1_45
P1_46:
    ds_read_b64_tr_b16 v[76:77], v4 offset:0
    ds_read_b64_tr_b16 v[78:79], v4 offset:512
    ds_read_b64_tr_b16 v[80:81], v4 offset:1024
    ds_read_b64_tr_b16 v[82:83], v4 offset:1536
    ds_read_b64_tr_b16 v[84:85], v4 offset:2048
    ds_read_b64_tr_b16 v[86:87], v4 offset:2560
    s_add_u32 s21, s21, 24
    s_cmp_eq_u32 s23, 0
    s_cbranch_scc1 P1_47
    s_mov_b32 s22, 4
P1_48:
    ds_read_b64 v[8:9], v2 offset:24
    s_waitcnt lgkmcnt(0)
    v_readfirstlane_b32 s16, v8
    v_readfirstlane_b32 s17, v9
    s_cmp_lg_u32 s16, 0
    s_cbranch_scc1 PC_31
    s_cmp_ge_u32 s17, s21
    s_cbranch_scc1 P1_49
    s_sub_u32 s14, s14, 1
    s_cbranch_scc1 L_END
    s_branch P1_48
P1_49:
    ds_read_b64_tr_b16 v[88:89], v4 offset:24576
    ds_read_b64_tr_b16 v[90:91], v4 offset:25088
    ds_read_b64_tr_b16 v[92:93], v4 offset:25600
    ds_read_b64_tr_b16 v[94:95], v4 offset:26112
    ds_read_b64_tr_b16 v[96:97], v4 offset:26624
    ds_read_b64_tr_b16 v[98:99], v4 offset:27136
    s_add_u32 s21, s21, 24
P1_47:
    s_mov_b32 s22, 5
P1_50:
    ds_read_b64 v[8:9], v2 offset:24
    s_waitcnt lgkmcnt(0)
    v_readfirstlane_b32 s16, v8
    v_readfirstlane_b32 s17, v9
    s_cmp_lg_u32 s16, 0
    s_cbranch_scc1 PC_31
    s_sub_u32 s14, s14, 1
    s_cbranch_scc1 L_END
    s_branch P1_50
PC_31:
    ds_read_b64 v[8:9], v2 offset:16
    s_mov_b32 s17, 0x3fb8aa3b
    s_waitcnt lgkmcnt(0)
    v_sub_f32 v20, v20, v8
    v_sub_f32 v21, v21, v8
    v_sub_f32 v22, v22, v8
    v_sub_f32 v23, v23, v8
    v_sub_f32 v24, v24, v8
    v_mul_f32 v20, s17, v20
    v_mul_f32 v21, s17, v21
    v_mul_f32 v22, s17, v22
    v_mul_f32 v23, s17, v23
    v_mul_f32 v24, s17, v24
    v_exp_f32 v20, v20
    v_exp_f32 v21, v21
    v_exp_f32 v22, v22
    v_exp_f32 v23, v23
    v_exp_f32 v24, v24
    s_nop 0
    v_mul_f32 v20, v20, v9
    v_mul_f32 v21, v21, v9
    v_mul_f32 v22, v22, v9
    v_mul_f32 v23, v23, v9
    v_mul_f32 v24, v24, v9
    v_cvt_pk_bf16_f32 v20, v20, v20
    v_cvt_pk_bf16_f32 v21, v21, v21
    v_cvt_pk_bf16_f32 v22, v22, v22
    v_cvt_pk_bf16_f32 v23, v23, v23
    v_cvt_pk_bf16_f32 v24, v24, v24
    s_mov_b32 exec_lo, 0x01010101
    s_mov_b32 exec_hi, 0x01010101
    ds_write_b16 v5, v20 offset:0
    ds_write_b16 v5, v21 offset:128
    ds_write_b16 v5, v22 offset:256
    ds_write_b16 v5, v23 offset:384
    s_cmp_eq_u32 s23, 0
    s_cbranch_scc1 P5_51
    ds_write_b16 v5, v24 offset:512
P5_51:
    s_mov_b64 exec, -1
    ds_read_b128 v[100:103], v6 offset:0
    ds_read_b128 v[104:107], v6 offset:128
    ds_read_b128 v[108:111], v6 offset:256
    ds_read_b128 v[112:115], v6 offset:384
    ds_read_b128 v[116:119], v6 offset:512
    s_waitcnt lgkmcnt(0)
    s_cmp_eq_u32 s22, 0
    s_cbranch_scc1 P2_33
    v_dot2c_f32_bf16 v26, v40, v100
    v_dot2c_f32_bf16 v27, v44, v100
    v_dot2c_f32_bf16 v28, v48, v100
    v_dot2c_f32_bf16 v26, v41, v101
    v_dot2c_f32_bf16 v27, v45, v101
    v_dot2c_f32_bf16 v28, v49, v101
    v_dot2c_f32_bf16 v26, v42, v102
    v_dot2c_f32_bf16 v27, v46, v102
    v_dot2c_f32_bf16 v28, v50, v102
    v_dot2c_f32_bf16 v26, v43, v103
    v_dot2c_f32_bf16 v27, v47, v103
    v_dot2c_f32_bf16 v28, v51, v103
    s_cmp_eq_u32 s22, 1
    s_cbranch_scc1 P2_34
    v_dot2c_f32_bf16 v26, v52, v104
    v_dot2c_f32_bf16 v27, v56, v104
    v_dot2c_f32_bf16 v28, v60, v104
    v_dot2c_f32_bf16 v26, v53, v105
    v_dot2c_f32_bf16 v27, v57, v105
    v_dot2c_f32_bf16 v28, v61, v105
    v_dot2c_f32_bf16 v26, v54, v106
    v_dot2c_f32_bf16 v27, v58, v106
    v_dot2c_f32_bf16 v28, v62, v106
    v_dot2c_f32_bf16 v26, v55, v107
    v_dot2c_f32_bf16 v27, v59, v107
    v_dot2c_f32_bf16 v28, v63, v107
    s_cmp_eq_u32 s22, 2
    s_cbranch_scc1 P2_35
    v_dot2c_f32_bf16 v26, v64, v108
    v_dot2c_f32_bf16 v27, v68, v108
    v_dot2c_f32_bf16 v28, v72, v108
    v_dot2c_f32_bf16 v26, v65, v109
    v_dot2c_f32_bf16 v27, v69, v109
    v_dot2c_f32_bf16 v28, v73, v109
    v_dot2c_f32_bf16 v26, v66, v110
    v_dot2c_f32_bf16 v27, v70, v110
    v_dot2c_f32_bf16 v28, v74, v110
    v_dot2c_f32_bf16 v26, v67, v111
    v_dot2c_f32_bf16 v27, v71, v111
    v_dot2c_f32_bf16 v28, v75, v111
    s_cmp_eq_u32 s22, 3
    s_cbranch_scc1 P2_36
    v_dot2c_f32_bf16 v26, v76, v112
    v_dot2c_f32_bf16 v27, v80, v112
    v_dot2c_f32_bf16 v28, v84, v112
    v_dot2c_f32_bf16 v26, v77, v113
    v_dot2c_f32_bf16 v27, v81, v113
    v_dot2c_f32_bf16 v28, v85, v113
    v_dot2c_f32_bf16 v26, v78, v114
    v_dot2c_f32_bf16 v27, v82, v114
    v_dot2c_f32_bf16 v28, v86, v114
    v_dot2c_f32_bf16 v26, v79, v115
    v_dot2c_f32_bf16 v27, v83, v115
    v_dot2c_f32_bf16 v28, v87, v115
    s_cmp_eq_u32 s22, 4
    s_cbranch_scc1 P2_37
    s_cmp_eq_u32 s23, 0
    s_cbranch_scc1 V5_52
    v_dot2c_f32_bf16 v26, v88, v116
    v_dot2c_f32_bf16 v27, v92, v116
    v_dot2c_f32_bf16 v28, v96, v116
    v_dot2c_f32_bf16 v26, v89, v117
    v_dot2c_f32_bf16 v27, v93, v117
    v_dot2c_f32_bf16 v28, v97, v117
    v_dot2c_f32_bf16 v26, v90, v118
    v_dot2c_f32_bf16 v27, v94, v118
    v_dot2c_f32_bf16 v28, v98, v118
    v_dot2c_f32_bf16 v26, v91, v119
    v_dot2c_f32_bf16 v27, v95, v119
    v_dot2c_f32_bf16 v28, v99, v119
V5_52:
    s_branch PE_32
P2_33:
W_53:
    ds_read_b32 v1, v2 offset:28
    s_waitcnt lgkmcnt(0)
    v_readfirstlane_b32 s16, v1
    s_cmp_ge_u32 s16, s21
    s_cbranch_scc1 WD_54
    s_sub_u32 s14, s14, 1
    s_cbranch_scc1 L_END
    s_branch W_53
WD_54:
    ds_read_b64_tr_b16 v[40:41], v3 offset:0
    ds_read_b64_tr_b16 v[42:43], v3 offset:512
    ds_read_b64_tr_b16 v[44:45], v3 offset:1024
    ds_read_b64_tr_b16 v[46:47], v3 offset:1536
    ds_read_b64_tr_b16 v[48:49], v3 offset:2048
    ds_read_b64_tr_b16 v[50:51], v3 offset:2560
    s_add_u32 s21, s21, 24
    s_waitcnt lgkmcnt(0)
    v_dot2c_f32_bf16 v26, v40, v100
    v_dot2c_f32_bf16 v27, v44, v100
    v_dot2c_f32_bf16 v28, v48, v100
    v_dot2c_f32_bf16 v26, v41, v101
    v_dot2c_f32_bf16 v27, v45, v101
    v_dot2c_f32_bf16 v28, v49, v101
    v_dot2c_f32_bf16 v26, v42, v102
    v_dot2c_f32_bf16 v27, v46, v102
    v_dot2c_f32_bf16 v28, v50, v102
    v_dot2c_f32_bf16 v26, v43, v103
    v_dot2c_f32_bf16 v27, v47, v103
    v_dot2c_f32_bf16 v28, v51, v103
P2_34:
W_55:
    ds_read_b32 v1, v2 offset:28
    s_waitcnt lgkmcnt(0)
    v_readfirstlane_b32 s16, v1
    s_cmp_ge_u32 s16, s21
    s_cbranch_scc1 WD_56
    s_sub_u32 s14, s14, 1
    s_cbranch_scc1 L_END
    s_branch W_55
WD_56:
    ds_read_b64_tr_b16 v[52:53], v3 offset:24576
    ds_read_b64_tr_b16 v[54:55], v3 offset:25088
    ds_read_b64_tr_b16 v[56:57], v3 offset:25600
    ds_read_b64_tr_b16 v[58:59], v3 offset:26112
    ds_read_b64_tr_b16 v[60:61], v3 offset:26624
    ds_read_b64_tr_b16 v[62:63], v3 offset:27136
    s_add_u32 s21, s21, 24
    s_waitcnt lgkmcnt(0)
    v_dot2c_f32_bf16 v26, v52, v104
    v_dot2c_f32_bf16 v27, v56, v104
    v_dot2c_f32_bf16 v28, v60, v104
    v_dot2c_f32_bf16 v26, v53, v105
    v_dot2c_f32_bf16 v27, v57, v105
    v_dot2c_f32_bf16 v28, v61, v105
    v_dot2c_f32_bf16 v26, v54, v106
    v_dot2c_f32_bf16 v27, v58, v106
    v_dot2c_f32_bf16 v28, v62, v106
    v_dot2c_f32_bf16 v26, v55, v107
    v_dot2c_f32_bf16 v27, v59, v107
    v_dot2c_f32_bf16 v28, v63, v107
P2_35:
W_57:
    ds_read_b32 v1, v2 offset:28
    s_waitcnt lgkmcnt(0)
    v_readfirstlane_b32 s16, v1
    s_cmp_ge_u32 s16, s21
    s_cbranch_scc1 WD_58
    s_sub_u32 s14, s14, 1
    s_cbranch_scc1 L_END
    s_branch W_57
WD_58:
    ds_read_b64_tr_b16 v[64:65], v3 offset:49152
    ds_read_b64_tr_b16 v[66:67], v3 offset:49664
    ds_read_b64_tr_b16 v[68:69], v3 offset:50176
    ds_read_b64_tr_b16 v[70:71], v3 offset:50688
    ds_read_b64_tr_b16 v[72:73], v3 offset:51200
    ds_read_b64_tr_b16 v[74:75], v3 offset:51712
    s_add_u32 s21, s21, 24
    s_waitcnt lgkmcnt(0)
    v_dot2c_f32_bf16 v26, v64, v108
    v_dot2c_f32_bf16 v27, v68, v108
    v_dot2c_f32_bf16 v28, v72, v108
    v_dot2c_f32_bf16 v26, v65, v109
    v_dot2c_f32_bf16 v27, v69, v109
    v_dot2c_f32_bf16 v28, v73, v109
    v_dot2c_f32_bf16 v26, v66, v110
    v_dot2c_f32_bf16 v27, v70, v110
    v_dot2c_f32_bf16 v28, v74, v110
    v_dot2c_f32_bf16 v26, v67, v111
    v_dot2c_f32_bf16 v27, v71, v111
    v_dot2c_f32_bf16 v28, v75, v111
P2_36:
W_59:
    ds_read_b32 v1, v2 offset:28
    s_waitcnt lgkmcnt(0)
    v_readfirstlane_b32 s16, v1
    s_cmp_ge_u32 s16, s21
    s_cbranch_scc1 WD_60
    s_sub_u32 s14, s14, 1
    s_cbranch_scc1 L_END
    s_branch W_59
WD_60:
    ds_read_b64_tr_b16 v[76:77], v4 offset:0
    ds_read_b64_tr_b16 v[78:79], v4 offset:512
    ds_read_b64_tr_b16 v[80:81], v4 offset:1024
    ds_read_b64_tr_b16 v[82:83], v4 offset:1536
    ds_read_b64_tr_b16 v[84:85], v4 offset:2048
    ds_read_b64_tr_b16 v[86:87], v4 offset:2560
    s_add_u32 s21, s21, 24
    s_waitcnt lgkmcnt(0)
    v_dot2c_f32_bf16 v26, v76, v112
    v_dot2c_f32_bf16 v27, v80, v112
    v_dot2c_f32_bf16 v28, v84, v112
    v_dot2c_f32_bf16 v26, v77, v113
    v_dot2c_f32_bf16 v27, v81, v113
    v_dot2c_f32_bf16 v28, v85, v113
    v_dot2c_f32_bf16 v26, v78, v114
    v_dot2c_f32_bf16 v27, v82, v114
    v_dot2c_f32_bf16 v28, v86, v114
    v_dot2c_f32_bf16 v26, v79, v115
    v_dot2c_f32_bf16 v27, v83, v115
    v_dot2c_f32_bf16 v28, v87, v115
P2_37:
    s_cmp_eq_u32 s23, 0
    s_cbranch_scc1 PE_32
W_61:
    ds_read_b32 v1, v2 offset:28
    s_waitcnt lgkmcnt(0)
    v_readfirstlane_b32 s16, v1
    s_cmp_ge_u32 s16, s21
    s_cbranch_scc1 WD_62
    s_sub_u32 s14, s14, 1
    s_cbranch_scc1 L_END
    s_branch W_61
WD_62:
    ds_read_b64_tr_b16 v[88:89], v4 offset:24576
    ds_read_b64_tr_b16 v[90:91], v4 offset:25088
    ds_read_b64_tr_b16 v[92:93], v4 offset:25600
    ds_read_b64_tr_b16 v[94:95], v4 offset:26112
    ds_read_b64_tr_b16 v[96:97], v4 offset:26624
    ds_read_b64_tr_b16 v[98:99], v4 offset:27136
    s_add_u32 s21, s21, 24
    s_waitcnt lgkmcnt(0)
    v_dot2c_f32_bf16 v26, v88, v116
    v_dot2c_f32_bf16 v27, v92, v116
    v_dot2c_f32_bf16 v28, v96, v116
    v_dot2c_f32_bf16 v26, v89, v117
    v_dot2c_f32_bf16 v27, v93, v117
    v_dot2c_f32_bf16 v28, v97, v117
    v_dot2c_f32_bf16 v26, v90, v118
    v_dot2c_f32_bf16 v27, v94, v118
    v_dot2c_f32_bf16 v28, v98, v118
    v_dot2c_f32_bf16 v26, v91, v119
    v_dot2c_f32_bf16 v27, v95, v119
    v_dot2c_f32_bf16 v28, v99, v119
PE_32:
    v_mov_b32 v1, 1
    s_nop 1
    ds_write_b96 v25, v[26:28]
    s_mov_b64 exec, 1
    ds_add_rtn_u32 v1, v2, v1 offset:12
    s_mov_b64 exec, -1
    s_waitcnt lgkmcnt(0)
    v_readfirstlane_b32 s16, v1
    s_cmp_lg_u32 s16, 7
    s_cbranch_scc1 NL_63
    ds_read_b96 v[40:42], v29 offset:0
    ds_read_b96 v[44:46], v29 offset:3072
    ds_read_b96 v[48:50], v29 offset:6144
    ds_read_b96 v[52:54], v29 offset:9216
    ds_read_b96 v[56:58], v29 offset:12288
    ds_read_b96 v[60:62], v29 offset:15360
    ds_read_b96 v[64:66], v29 offset:18432
    ds_read_b96 v[68:70], v29 offset:21504
    s_waitcnt lgkmcnt(0)
    v_add_f32 v40, v40, v44
    v_add_f32 v41, v41, v45
    v_add_f32 v42, v42, v46
    v_add_f32 v48, v48, v52
    v_add_f32 v49, v49, v53
    v_add_f32 v50, v50, v54
    v_add_f32 v56, v56, v60
    v_add_f32 v57, v57, v61
    v_add_f32 v58, v58, v62
    v_add_f32 v64, v64, v68
    v_add_f32 v65, v65, v69
    v_add_f32 v66, v66, v70
    v_add_f32 v40, v40, v48
    v_add_f32 v41, v41, v49
    v_add_f32 v42, v42, v50
    v_add_f32 v56, v56, v64
    v_add_f32 v57, v57, v65
    v_add_f32 v58, v58, v66
    v_add_f32 v26, v40, v56
    v_add_f32 v27, v41, v57
    v_add_f32 v28, v42, v58
    v_min_u32 v26, -2, v26
    v_min_u32 v27, -2, v27
    v_min_u32 v28, -2, v28
    s_cmp_lg_u32 s15, 0
    s_cbranch_scc1 SF_64
    buffer_store_dwordx3 v[26:28], v30, s[64:67], s68 offen sc1
    s_branch SD_65
SF_64:
    buffer_store_dwordx3 v[26:28], v30, s[64:67], s68 offen
SD_65:
NL_63:
W_66:
    ds_read_b32 v1, v2 offset:28
    s_waitcnt lgkmcnt(0)
    v_readfirstlane_b32 s16, v1
    s_cmp_ge_u32 s16, s95
    s_cbranch_scc1 WD_67
    s_sub_u32 s14, s14, 1
    s_cbranch_scc1 L_END
    s_branch W_66
WD_67:
    ds_read_b64_tr_b16 v[124:125], v120 offset:0
    ds_read_b64_tr_b16 v[126:127], v120 offset:512
    ds_read_b64_tr_b16 v[128:129], v120 offset:10240
    ds_read_b64_tr_b16 v[130:131], v120 offset:10752
    ds_read_b64_tr_b16 v[132:133], v120 offset:20480
    ds_read_b64_tr_b16 v[134:135], v120 offset:20992
    v_mov_b32 v156, 0
    v_mov_b32 v157, 0
    v_mov_b32 v158, 0
    v_mov_b32 v159, 0
    s_cmp_lt_u32 s12, 4
    s_cbranch_scc1 WS_68
    ds_read_b64_tr_b16 v[136:137], v120 offset:30720
    ds_read_b64_tr_b16 v[138:139], v120 offset:31232
WS_68:
W_69:
    ds_read_b32 v1, v2 offset:36
    s_waitcnt lgkmcnt(0)
    v_readfirstlane_b32 s16, v1
    s_cmp_ge_u32 s16, 1
    s_cbranch_scc1 WD_70
    s_sub_u32 s14, s14, 1
    s_cbranch_scc1 L_END
    s_branch W_69
WD_70:
    s_sub_u32 s15, s16, 1
WO_71:
    ds_read_b128 v[140:143], v122 offset:0
    ds_read_b128 v[144:147], v122 offset:16
    ds_read_b128 v[148:151], v122 offset:32
    ds_read_b128 v[152:155], v122 offset:48
    s_waitcnt lgkmcnt(0)
    v_max3_u32 v1, v140, v144, v148
    v_max_u32 v1, v1, v152
    v_cmp_eq_u32 vcc, -1, v1
    s_cbranch_vccz WOD_72
    s_sub_u32 s14, s14, 1
    s_cbranch_scc1 L_END
    s_branch WO_71
WOD_72:
    s_cmp_lt_u32 s12, 4
    s_cbranch_scc1 WS_73
    v_dot2c_f32_bf16 v156, v124, v140
    v_dot2c_f32_bf16 v157, v128, v144
    v_dot2c_f32_bf16 v158, v132, v148
    v_dot2c_f32_bf16 v159, v136, v152
    v_dot2c_f32_bf16 v156, v125, v141
    v_dot2c_f32_bf16 v157, v129, v145
    v_dot2c_f32_bf16 v158, v133, v149
    v_dot2c_f32_bf16 v159, v137, v153
    v_dot2c_f32_bf16 v156, v126, v142
    v_dot2c_f32_bf16 v157, v130, v146
    v_dot2c_f32_bf16 v158, v134, v150
    v_dot2c_f32_bf16 v159, v138, v154
    v_dot2c_f32_bf16 v156, v127, v143
    v_dot2c_f32_bf16 v157, v131, v147
    v_dot2c_f32_bf16 v158, v135, v151
    v_dot2c_f32_bf16 v159, v139, v155
    s_branch WS_74
WS_73:
    v_dot2c_f32_bf16 v156, v124, v140
    v_dot2c_f32_bf16 v157, v128, v144
    v_dot2c_f32_bf16 v158, v132, v148
    v_dot2c_f32_bf16 v156, v125, v141
    v_dot2c_f32_bf16 v157, v129, v145
    v_dot2c_f32_bf16 v158, v133, v149
    v_dot2c_f32_bf16 v156, v126, v142
    v_dot2c_f32_bf16 v157, v130, v146
    v_dot2c_f32_bf16 v158, v134, v150
    v_dot2c_f32_bf16 v156, v127, v143
    v_dot2c_f32_bf16 v157, v131, v147
    v_dot2c_f32_bf16 v158, v135, v151
WS_74:
    s_nop 1
    v_add_f32 v156, v156, v157
    v_add_f32 v158, v158, v159
    v_add_f32 v156, v156, v158
    v_min_u32 v156, -2, v156
    s_cmp_lg_u32 s15, 0
    s_cbranch_scc1 SF_75
    buffer_store_dword v156, v121, s[64:67], s94 offen sc1
    s_branch SD_76
SF_75:
    buffer_store_dword v156, v121, s[64:67], s94 offen
SD_76:
    s_branch L_END
L_LOADER:
    v_lshlrev_b32 v4, 4, v0
    s_lshl_b32 s17, s6, 3
    v_mov_b32 v10, s17
    s_getreg_b32 s68, hwreg(HW_REG_XCC_ID)
    s_and_b32 s68, s68, 15
    s_add_u32 s68, s68, 1
    v_add_u32 v5, 160256, v4
W_77:
    ds_read_b32 v1, v2 offset:0
    s_waitcnt lgkmcnt(0)
    v_readfirstlane_b32 s16, v1
    s_cmp_ge_u32 s16, 1
    s_cbranch_scc1 WD_78
    s_sub_u32 s14, s14, 1
    s_cbranch_scc1 L_END
    s_branch W_77
WD_78:
    buffer_load_dword v11, v10, s[60:63], 0 offen sc1
    v_lshrrev_b32 v6, 5, v0
    v_lshlrev_b32 v6, 8, v6
    v_bfe_u32 v7, v0, 2, 2
    v_lshl_add_u32 v6, v7, 6, v6
    v_bfe_u32 v7, v0, 4, 1
    v_lshl_add_u32 v6, v7, 5, v6
    v_and_b32 v7, 3, v0
    v_lshl_add_u32 v6, v7, 3, v6
    v_add_u32 v6, 116736, v6
    s_add_u32 s17, s11, 0
    s_lshl_b32 s17, s17, 4
    s_add_u32 s17, s17, 157696
    v_mov_b32 v7, s17
    v_mov_b32 v12, 0
    v_mov_b32 v13, 0
    v_mov_b32 v14, 0
    s_waitcnt vmcnt(16)
    ds_read_b128 v[76:79], v7 offset:0
    ds_read_b64_tr_b16 v[80:81], v6 offset:0
    ds_read_b64_tr_b16 v[82:83], v6 offset:512
    ds_read_b64_tr_b16 v[84:85], v6 offset:1024
    ds_read_b64_tr_b16 v[86:87], v6 offset:1536
    ds_read_b64_tr_b16 v[88:89], v6 offset:2048
    ds_read_b64_tr_b16 v[90:91], v6 offset:2560
    s_waitcnt vmcnt(13)
    ds_read_b128 v[92:95], v7 offset:16
    ds_read_b64_tr_b16 v[96:97], v6 offset:3072
    ds_read_b64_tr_b16 v[98:99], v6 offset:3584
    ds_read_b64_tr_b16 v[100:101], v6 offset:4096
    ds_read_b64_tr_b16 v[102:103], v6 offset:4608
    ds_read_b64_tr_b16 v[104:105], v6 offset:5120
    ds_read_b64_tr_b16 v[106:107], v6 offset:5632
    s_waitcnt lgkmcnt(7)
    v_dot2c_f32_bf16 v12, v80, v76
    v_dot2c_f32_bf16 v13, v84, v76
    v_dot2c_f32_bf16 v14, v88, v76
    v_dot2c_f32_bf16 v12, v81, v77
    v_dot2c_f32_bf16 v13, v85, v77
    v_dot2c_f32_bf16 v14, v89, v77
    v_dot2c_f32_bf16 v12, v82, v78
    v_dot2c_f32_bf16 v13, v86, v78
    v_dot2c_f32_bf16 v14, v90, v78
    v_dot2c_f32_bf16 v12, v83, v79
    v_dot2c_f32_bf16 v13, v87, v79
    v_dot2c_f32_bf16 v14, v91, v79
    s_waitcnt vmcnt(10)
    ds_read_b128 v[76:79], v7 offset:32
    ds_read_b64_tr_b16 v[80:81], v6 offset:6144
    ds_read_b64_tr_b16 v[82:83], v6 offset:6656
    ds_read_b64_tr_b16 v[84:85], v6 offset:7168
    ds_read_b64_tr_b16 v[86:87], v6 offset:7680
    ds_read_b64_tr_b16 v[88:89], v6 offset:8192
    ds_read_b64_tr_b16 v[90:91], v6 offset:8704
    s_waitcnt lgkmcnt(7)
    v_dot2c_f32_bf16 v12, v96, v92
    v_dot2c_f32_bf16 v13, v100, v92
    v_dot2c_f32_bf16 v14, v104, v92
    v_dot2c_f32_bf16 v12, v97, v93
    v_dot2c_f32_bf16 v13, v101, v93
    v_dot2c_f32_bf16 v14, v105, v93
    v_dot2c_f32_bf16 v12, v98, v94
    v_dot2c_f32_bf16 v13, v102, v94
    v_dot2c_f32_bf16 v14, v106, v94
    v_dot2c_f32_bf16 v12, v99, v95
    v_dot2c_f32_bf16 v13, v103, v95
    v_dot2c_f32_bf16 v14, v107, v95
    s_waitcnt vmcnt(7)
    ds_read_b128 v[92:95], v7 offset:48
    ds_read_b64_tr_b16 v[96:97], v6 offset:9216
    ds_read_b64_tr_b16 v[98:99], v6 offset:9728
    ds_read_b64_tr_b16 v[100:101], v6 offset:10240
    ds_read_b64_tr_b16 v[102:103], v6 offset:10752
    ds_read_b64_tr_b16 v[104:105], v6 offset:11264
    ds_read_b64_tr_b16 v[106:107], v6 offset:11776
    s_waitcnt lgkmcnt(7)
    v_dot2c_f32_bf16 v12, v80, v76
    v_dot2c_f32_bf16 v13, v84, v76
    v_dot2c_f32_bf16 v14, v88, v76
    v_dot2c_f32_bf16 v12, v81, v77
    v_dot2c_f32_bf16 v13, v85, v77
    v_dot2c_f32_bf16 v14, v89, v77
    v_dot2c_f32_bf16 v12, v82, v78
    v_dot2c_f32_bf16 v13, v86, v78
    v_dot2c_f32_bf16 v14, v90, v78
    v_dot2c_f32_bf16 v12, v83, v79
    v_dot2c_f32_bf16 v13, v87, v79
    v_dot2c_f32_bf16 v14, v91, v79
    s_waitcnt vmcnt(4)
    ds_read_b128 v[76:79], v7 offset:64
    ds_read_b64_tr_b16 v[80:81], v6 offset:12288
    ds_read_b64_tr_b16 v[82:83], v6 offset:12800
    ds_read_b64_tr_b16 v[84:85], v6 offset:13312
    ds_read_b64_tr_b16 v[86:87], v6 offset:13824
    ds_read_b64_tr_b16 v[88:89], v6 offset:14336
    ds_read_b64_tr_b16 v[90:91], v6 offset:14848
    s_waitcnt lgkmcnt(7)
    v_dot2c_f32_bf16 v12, v96, v92
    v_dot2c_f32_bf16 v13, v100, v92
    v_dot2c_f32_bf16 v14, v104, v92
    v_dot2c_f32_bf16 v12, v97, v93
    v_dot2c_f32_bf16 v13, v101, v93
    v_dot2c_f32_bf16 v14, v105, v93
    v_dot2c_f32_bf16 v12, v98, v94
    v_dot2c_f32_bf16 v13, v102, v94
    v_dot2c_f32_bf16 v14, v106, v94
    v_dot2c_f32_bf16 v12, v99, v95
    v_dot2c_f32_bf16 v13, v103, v95
    v_dot2c_f32_bf16 v14, v107, v95
    s_waitcnt vmcnt(1)
    ds_read_b128 v[92:95], v7 offset:80
    ds_read_b64_tr_b16 v[96:97], v6 offset:15360
    ds_read_b64_tr_b16 v[98:99], v6 offset:15872
    ds_read_b64_tr_b16 v[100:101], v6 offset:16384
    ds_read_b64_tr_b16 v[102:103], v6 offset:16896
    ds_read_b64_tr_b16 v[104:105], v6 offset:17408
    ds_read_b64_tr_b16 v[106:107], v6 offset:17920
    s_waitcnt lgkmcnt(7)
    v_dot2c_f32_bf16 v12, v80, v76
    v_dot2c_f32_bf16 v13, v84, v76
    v_dot2c_f32_bf16 v14, v88, v76
    v_dot2c_f32_bf16 v12, v81, v77
    v_dot2c_f32_bf16 v13, v85, v77
    v_dot2c_f32_bf16 v14, v89, v77
    v_dot2c_f32_bf16 v12, v82, v78
    v_dot2c_f32_bf16 v13, v86, v78
    v_dot2c_f32_bf16 v14, v90, v78
    v_dot2c_f32_bf16 v12, v83, v79
    v_dot2c_f32_bf16 v13, v87, v79
    v_dot2c_f32_bf16 v14, v91, v79
    s_waitcnt lgkmcnt(0)
    v_dot2c_f32_bf16 v12, v96, v92
    v_dot2c_f32_bf16 v13, v100, v92
    v_dot2c_f32_bf16 v14, v104, v92
    v_dot2c_f32_bf16 v12, v97, v93
    v_dot2c_f32_bf16 v13, v101, v93
    v_dot2c_f32_bf16 v14, v105, v93
    v_dot2c_f32_bf16 v12, v98, v94
    v_dot2c_f32_bf16 v13, v102, v94
    v_dot2c_f32_bf16 v14, v106, v94
    v_dot2c_f32_bf16 v12, v99, v95
    v_dot2c_f32_bf16 v13, v103, v95
    v_dot2c_f32_bf16 v14, v107, v95
    s_nop 2
    ds_write_b96 v5, v[12:14]
    v_mov_b32 v1, 1
    ds_write_b32 v2, v1 offset:32
    v_lshrrev_b32 v8, 5, v0
    v_lshlrev_b32 v8, 2, v8
    v_bfe_u32 v9, v0, 2, 2
    v_or_b32 v8, v8, v9
    v_mul_u32_u24 v4, 384, v8
    v_bfe_u32 v9, v0, 4, 1
    v_lshl_add_u32 v4, v9, 6, v4
    v_and_b32 v9, 3, v0
    v_lshl_add_u32 v4, v9, 4, v4
    v_lshrrev_b32 v8, 5, v0
    v_lshlrev_b32 v8, 2, v8
    v_bfe_u32 v9, v0, 2, 2
    v_or_b32 v8, v8, v9
    v_mul_u32_u24 v7, 1280, v8
    v_bfe_u32 v9, v0, 4, 1
    v_lshl_add_u32 v7, v9, 6, v7
    v_and_b32 v9, 3, v0
    v_lshl_add_u32 v7, v9, 4, v7
    v_add_u32 v5, 128, v4
    v_add_u32 v6, 256, v4
GF_79:
    s_waitcnt vmcnt(0)
    v_readfirstlane_b32 s16, v11
    s_cmp_ge_u32 s16, 1
    s_cbranch_scc1 GD_80
    s_sub_u32 s14, s14, 1
    s_cbranch_scc1 L_END
    buffer_load_dword v11, v10, s[60:63], 0 offen sc1
    s_branch GF_79
GD_80:
    s_cmp_eq_u32 s16, s68
    s_cselect_b32 s17, 2, 1
    v_mov_b32 v1, s17
    ds_write_b32 v2, v1 offset:44
    v_lshlrev_b32 v10, 3, v0
    s_lshl_b32 s69, s4, 5
    s_mov_b32 exec_lo, 0xf
    s_mov_b32 exec_hi, 0
    buffer_load_dword v11, v10, s[60:63], s69 offen sc1
    s_mov_b64 exec, -1
    v_lshrrev_b32 v120, 5, v0
    v_lshlrev_b32 v120, 8, v120
    v_bfe_u32 v121, v0, 2, 2
    v_lshl_add_u32 v120, v121, 6, v120
    v_bfe_u32 v121, v0, 4, 1
    v_lshl_add_u32 v120, v121, 5, v120
    v_and_b32 v121, 3, v0
    v_lshl_add_u32 v120, v121, 3, v120
    s_lshl_b32 s17, s3, 10
    s_add_u32 s17, s17, 116736
    v_add_u32 v120, s17, v120
    s_mul_i32 s95, s8, 3
    s_mul_i32 s19, s12, 10
    s_add_u32 s95, s95, s19
    s_mul_i32 s17, s4, 73728
    s_mul_i32 s18, s5, 2560
    s_add_u32 s17, s17, s18
    s_lshl_b32 s18, s3, 8
    s_add_u32 s17, s17, s18
    s_add_u32 s94, s17, 589824
    v_lshlrev_b32 v121, 2, v0
    v_mov_b32 v122, 160000
    v_lshlrev_b32 v12, 10, v0
    s_lshl_b32 s70, s4, 15
    s_sub_u32 s68, s68, 1
W_81:
    ds_read_b32 v1, v2 offset:4
    s_waitcnt lgkmcnt(0)
    v_readfirstlane_b32 s16, v1
    s_cmp_ge_u32 s16, 8
    s_cbranch_scc1 WD_82
    s_sleep 1
    s_sub_u32 s14, s14, 1
    s_cbranch_scc1 L_END
    s_branch W_81
WD_82:
    s_mov_b32 exec_lo, 0xf
    s_mov_b32 exec_hi, 0
GF_83:
    s_waitcnt vmcnt(0)
    v_cmp_eq_u32 vcc, 0, v11
    s_cmp_eq_u64 vcc, 0
    s_cbranch_scc1 GD_84
    s_sub_u32 s14, s14, 1
    s_cbranch_scc1 L_END
    buffer_load_dword v11, v10, s[60:63], s69 offen sc1
    s_branch GF_83
GD_84:
    s_mov_b64 exec, -1
    s_mul_i32 s20, s6, 3145728
    s_mul_i32 s21, s9, 3072
    s_add_u32 s20, s20, s21
    s_add_u32 s20, s20, 2359296
    s_mov_b32 m0, 0
    s_mov_b32 s22, 0
    s_mov_b32 s19, 0
    s_mov_b32 s21, s8
LV_85:
    buffer_load_dwordx4 v4, s[32:35], s20 offen nt lds
    s_add_u32 m0, m0, 1024
    s_nop 0
    buffer_load_dwordx4 v5, s[32:35], s20 offen nt lds
    s_add_u32 m0, m0, 1024
    s_nop 0
    buffer_load_dwordx4 v6, s[32:35], s20 offen nt lds
    s_add_u32 m0, m0, 1024
    s_add_u32 s20, s20, 3072
    s_add_u32 s22, s22, 3
    s_sub_i32 s23, s22, 24
    s_max_i32 s19, s19, s23
    v_mov_b32 v1, s19
    ds_read_b32 v14, v2 offset:24
    s_waitcnt vmcnt(24)
    ds_write_b32 v2, v1 offset:28
    s_waitcnt lgkmcnt(1)
    v_readfirstlane_b32 s16, v14
    s_cmp_eq_u32 s16, 0
    s_cbranch_scc1 LN_94
    s_sub_u32 s21, s21, 1
    s_cmp_lg_u32 s21, 0
    s_cbranch_scc1 LV_86
    s_branch LVE_88
LN_94:
    s_sub_u32 s21, s21, 1
    s_cmp_lg_u32 s21, 0
    s_cbranch_scc1 LV_85
LVE_87:
W_95:
    ds_read_b32 v1, v2 offset:8
    s_waitcnt lgkmcnt(0)
    v_readfirstlane_b32 s16, v1
    s_cmp_ge_u32 s16, 1
    s_cbranch_scc1 WD_96
    s_sub_u32 s14, s14, 1
    s_cbranch_scc1 L_END
    s_branch W_95
WD_96:
    s_mul_i32 s20, s6, 24
    s_add_u32 s20, s20, s13
    s_mul_i32 s20, s20, 10240
    s_mov_b32 m0, 116736
    s_lshl_b32 s21, s12, 1
    s_mov_b32 s17, 0
LW_89:
    buffer_load_dwordx4 v7, s[40:43], s20 offen nt lds
    s_add_u32 m0, m0, 1024
    s_add_u32 s20, s20, 128
    buffer_load_dwordx4 v7, s[40:43], s20 offen nt lds
    s_add_u32 m0, m0, 1024
    s_add_u32 s20, s20, 128
    buffer_load_dwordx4 v7, s[40:43], s20 offen nt lds
    s_add_u32 m0, m0, 1024
    s_add_u32 s20, s20, 128
    buffer_load_dwordx4 v7, s[40:43], s20 offen nt lds
    s_add_u32 m0, m0, 1024
    s_add_u32 s20, s20, 128
    buffer_load_dwordx4 v7, s[40:43], s20 offen nt lds
    s_add_u32 m0, m0, 1024
    s_add_u32 s20, s20, 128
    s_xor_b32 s17, s17, 1
    s_cselect_b32 s18, 0, 8960
    s_add_u32 s20, s20, s18
    s_add_u32 s22, s22, 5
    s_sub_i32 s23, s22, 24
    s_max_i32 s19, s19, s23
    v_mov_b32 v1, s19
    ds_read_b32 v14, v2 offset:24
    s_waitcnt vmcnt(24)
    ds_write_b32 v2, v1 offset:28
    s_waitcnt lgkmcnt(1)
    v_readfirstlane_b32 s16, v14
    s_cmp_eq_u32 s16, 0
    s_cbranch_scc1 LN_97
    s_sub_u32 s21, s21, 1
    s_cmp_lg_u32 s21, 0
    s_cbranch_scc1 LW_90
    s_branch LWE_92
LN_97:
    s_sub_u32 s21, s21, 1
    s_cmp_lg_u32 s21, 0
    s_cbranch_scc1 LW_89
    s_branch LWE_92
LV_86:
    buffer_load_dwordx4 v4, s[32:35], s20 offen nt lds
    s_add_u32 m0, m0, 1024
    s_nop 0
    buffer_load_dwordx4 v5, s[32:35], s20 offen nt lds
    s_add_u32 m0, m0, 1024
    s_nop 0
    buffer_load_dwordx4 v6, s[32:35], s20 offen nt lds
    s_add_u32 m0, m0, 1024
    s_add_u32 s20, s20, 3072
    s_add_u32 s22, s22, 3
    s_sub_i32 s23, s22, 48
    s_max_i32 s19, s19, s23
    v_mov_b32 v1, s19
    s_waitcnt vmcnt(48)
    ds_write_b32 v2, v1 offset:28
    s_sub_u32 s21, s21, 1
    s_cmp_lg_u32 s21, 0
    s_cbranch_scc1 LV_86
LVE_88:
W_98:
    ds_read_b32 v1, v2 offset:8
    s_waitcnt lgkmcnt(0)
    v_readfirstlane_b32 s16, v1
    s_cmp_ge_u32 s16, 1
    s_cbranch_scc1 WD_99
    s_sub_u32 s14, s14, 1
    s_cbranch_scc1 L_END
    s_branch W_98
WD_99:
    s_mul_i32 s20, s6, 24
    s_add_u32 s20, s20, s13
    s_mul_i32 s20, s20, 10240
    s_mov_b32 m0, 116736
    s_lshl_b32 s21, s12, 1
    s_mov_b32 s17, 0
LW_90:
    buffer_load_dwordx4 v7, s[40:43], s20 offen nt lds
    s_add_u32 m0, m0, 1024
    s_add_u32 s20, s20, 128
    buffer_load_dwordx4 v7, s[40:43], s20 offen nt lds
    s_add_u32 m0, m0, 1024
    s_add_u32 s20, s20, 128
    buffer_load_dwordx4 v7, s[40:43], s20 offen nt lds
    s_add_u32 m0, m0, 1024
    s_add_u32 s20, s20, 128
    buffer_load_dwordx4 v7, s[40:43], s20 offen nt lds
    s_add_u32 m0, m0, 1024
    s_add_u32 s20, s20, 128
    buffer_load_dwordx4 v7, s[40:43], s20 offen nt lds
    s_add_u32 m0, m0, 1024
    s_add_u32 s20, s20, 128
    s_xor_b32 s17, s17, 1
    s_cselect_b32 s18, 0, 8960
    s_add_u32 s20, s20, s18
    s_add_u32 s22, s22, 5
    s_sub_i32 s23, s22, 48
    s_max_i32 s19, s19, s23
    v_mov_b32 v1, s19
    s_waitcnt vmcnt(48)
    ds_write_b32 v2, v1 offset:28
    s_sub_u32 s21, s21, 1
    s_cmp_lg_u32 s21, 0
    s_cbranch_scc1 LW_90
LWE_92:
    v_mov_b32 v13, s68
    s_mov_b64 exec, 1
    buffer_load_dword v11, v10, s[60:63], s69 offen offset:28 sc1
    s_mov_b32 exec_lo, 0x7f7f7f7f
    buffer_load_dword v13, v12, s[64:67], s70 offen offset:12 sc1
    s_mov_b64 exec, -1
    s_sub_i32 s23, s22, 45
    s_max_i32 s19, s19, s23
    v_mov_b32 v1, s19
    s_waitcnt vmcnt(47)
    ds_write_b32 v2, v1 offset:28
    s_sub_i32 s23, s22, 42
    s_max_i32 s19, s19, s23
    v_mov_b32 v1, s19
    s_waitcnt vmcnt(44)
    ds_write_b32 v2, v1 offset:28
    s_sub_i32 s23, s22, 39
    s_max_i32 s19, s19, s23
    v_mov_b32 v1, s19
    s_waitcnt vmcnt(41)
    ds_write_b32 v2, v1 offset:28
    s_sub_i32 s23, s22, 36
    s_max_i32 s19, s19, s23
    v_mov_b32 v1, s19
    s_waitcnt vmcnt(38)
    ds_write_b32 v2, v1 offset:28
    s_sub_i32 s23, s22, 33
    s_max_i32 s19, s19, s23
    v_mov_b32 v1, s19
    s_waitcnt vmcnt(35)
    ds_write_b32 v2, v1 offset:28
    s_sub_i32 s23, s22, 30
    s_max_i32 s19, s19, s23
    v_mov_b32 v1, s19
    s_waitcnt vmcnt(32)
    ds_write_b32 v2, v1 offset:28
    s_sub_i32 s23, s22, 27
    s_max_i32 s19, s19, s23
    v_mov_b32 v1, s19
    s_waitcnt vmcnt(29)
    ds_write_b32 v2, v1 offset:28
    s_sub_i32 s23, s22, 24
    s_max_i32 s19, s19, s23
    v_mov_b32 v1, s19
    s_waitcnt vmcnt(26)
    ds_write_b32 v2, v1 offset:28
    s_sub_i32 s23, s22, 21
    s_max_i32 s19, s19, s23
    v_mov_b32 v1, s19
    s_waitcnt vmcnt(23)
    ds_write_b32 v2, v1 offset:28
    s_sub_i32 s23, s22, 18
    s_max_i32 s19, s19, s23
    v_mov_b32 v1, s19
    s_waitcnt vmcnt(20)
    ds_write_b32 v2, v1 offset:28
    s_sub_i32 s23, s22, 15
    s_max_i32 s19, s19, s23
    v_mov_b32 v1, s19
    s_waitcnt vmcnt(17)
    ds_write_b32 v2, v1 offset:28
    s_sub_i32 s23, s22, 12
    s_max_i32 s19, s19, s23
    v_mov_b32 v1, s19
    s_waitcnt vmcnt(14)
    ds_write_b32 v2, v1 offset:28
    s_sub_i32 s23, s22, 9
    s_max_i32 s19, s19, s23
    v_mov_b32 v1, s19
    s_waitcnt vmcnt(11)
    ds_write_b32 v2, v1 offset:28
    s_sub_i32 s23, s22, 6
    s_max_i32 s19, s19, s23
    v_mov_b32 v1, s19
    s_waitcnt vmcnt(8)
    ds_write_b32 v2, v1 offset:28
    s_sub_i32 s23, s22, 3
    s_max_i32 s19, s19, s23
    v_mov_b32 v1, s19
    s_waitcnt vmcnt(5)
    ds_write_b32 v2, v1 offset:28
    s_sub_i32 s23, s22, 0
    s_max_i32 s19, s19, s23
    v_mov_b32 v1, s19
    s_waitcnt vmcnt(2)
    ds_write_b32 v2, v1 offset:28
GF_100:
    s_waitcnt vmcnt(0)
    v_readfirstlane_b32 s16, v11
    s_cmp_lg_u32 s16, 0
    s_cbranch_scc1 GD_101
    s_sub_u32 s14, s14, 1
    s_cbranch_scc1 L_END
    s_mov_b64 exec, 1
    buffer_load_dword v11, v10, s[60:63], s69 offen offset:28 sc1
    s_mov_b64 exec, -1
    s_branch GF_100
GD_101:
    v_cmp_ne_u32 vcc, s68, v13
    s_cmp_eq_u64 vcc, 0
    s_cselect_b32 s17, 2, 1
    v_mov_b32 v1, s17
    ds_write_b32 v2, v1 offset:36
W_102:
    ds_read_b32 v1, v2 offset:28
    s_waitcnt lgkmcnt(0)
    v_readfirstlane_b32 s16, v1
    s_cmp_ge_u32 s16, s95
    s_cbranch_scc1 WD_103
    s_sub_u32 s14, s14, 1
    s_cbranch_scc1 L_END
    s_branch W_102
WD_103:
    ds_read_b64_tr_b16 v[124:125], v120 offset:0
    ds_read_b64_tr_b16 v[126:127], v120 offset:512
    ds_read_b64_tr_b16 v[128:129], v120 offset:10240
    ds_read_b64_tr_b16 v[130:131], v120 offset:10752
    ds_read_b64_tr_b16 v[132:133], v120 offset:20480
    ds_read_b64_tr_b16 v[134:135], v120 offset:20992
    v_mov_b32 v156, 0
    v_mov_b32 v157, 0
    v_mov_b32 v158, 0
    v_mov_b32 v159, 0
    s_cmp_lt_u32 s12, 4
    s_cbranch_scc1 WS_104
    ds_read_b64_tr_b16 v[136:137], v120 offset:30720
    ds_read_b64_tr_b16 v[138:139], v120 offset:31232
WS_104:
W_105:
    ds_read_b32 v1, v2 offset:36
    s_waitcnt lgkmcnt(0)
    v_readfirstlane_b32 s16, v1
    s_cmp_ge_u32 s16, 1
    s_cbranch_scc1 WD_106
    s_sub_u32 s14, s14, 1
    s_cbranch_scc1 L_END
    s_branch W_105
WD_106:
    s_sub_u32 s15, s16, 1
WO_107:
    ds_read_b128 v[140:143], v122 offset:0
    ds_read_b128 v[144:147], v122 offset:16
    ds_read_b128 v[148:151], v122 offset:32
    ds_read_b128 v[152:155], v122 offset:48
    s_waitcnt lgkmcnt(0)
    v_max3_u32 v1, v140, v144, v148
    v_max_u32 v1, v1, v152
    v_cmp_eq_u32 vcc, -1, v1
    s_cbranch_vccz WOD_108
    s_sub_u32 s14, s14, 1
    s_cbranch_scc1 L_END
    s_branch WO_107
WOD_108:
    s_cmp_lt_u32 s12, 4
    s_cbranch_scc1 WS_109
    v_dot2c_f32_bf16 v156, v124, v140
    v_dot2c_f32_bf16 v157, v128, v144
    v_dot2c_f32_bf16 v158, v132, v148
    v_dot2c_f32_bf16 v159, v136, v152
    v_dot2c_f32_bf16 v156, v125, v141
    v_dot2c_f32_bf16 v157, v129, v145
    v_dot2c_f32_bf16 v158, v133, v149
    v_dot2c_f32_bf16 v159, v137, v153
    v_dot2c_f32_bf16 v156, v126, v142
    v_dot2c_f32_bf16 v157, v130, v146
    v_dot2c_f32_bf16 v158, v134, v150
    v_dot2c_f32_bf16 v159, v138, v154
    v_dot2c_f32_bf16 v156, v127, v143
    v_dot2c_f32_bf16 v157, v131, v147
    v_dot2c_f32_bf16 v158, v135, v151
    v_dot2c_f32_bf16 v159, v139, v155
    s_branch WS_110
WS_109:
    v_dot2c_f32_bf16 v156, v124, v140
    v_dot2c_f32_bf16 v157, v128, v144
    v_dot2c_f32_bf16 v158, v132, v148
    v_dot2c_f32_bf16 v156, v125, v141
    v_dot2c_f32_bf16 v157, v129, v145
    v_dot2c_f32_bf16 v158, v133, v149
    v_dot2c_f32_bf16 v156, v126, v142
    v_dot2c_f32_bf16 v157, v130, v146
    v_dot2c_f32_bf16 v158, v134, v150
    v_dot2c_f32_bf16 v156, v127, v143
    v_dot2c_f32_bf16 v157, v131, v147
    v_dot2c_f32_bf16 v158, v135, v151
WS_110:
    s_nop 1
    v_add_f32 v156, v156, v157
    v_add_f32 v158, v158, v159
    v_add_f32 v156, v156, v158
    v_min_u32 v156, -2, v156
    s_cmp_lg_u32 s15, 0
    s_cbranch_scc1 SF_111
    buffer_store_dword v156, v121, s[64:67], s94 offen sc1
    s_branch SD_112
SF_111:
    buffer_store_dword v156, v121, s[64:67], s94 offen
SD_112:
    s_branch L_END
L_COMM:
    s_lshl_b32 s20, s6, 13
    s_lshl_b32 s21, s7, 10
    s_add_u32 s21, s20, s21
    s_add_u32 s71, s20, 4096
    v_lshlrev_b32 v4, 4, v0
    s_getreg_b32 s68, hwreg(HW_REG_XCC_ID)
    s_and_b32 s68, s68, 15
    v_mov_b32 v29, s68
    s_cmp_lt_u32 s10, 12
    s_cbranch_scc1 X_113
    s_waitcnt vmcnt(18)
    s_branch X_114
X_113:
    s_waitcnt vmcnt(15)
X_114:
    v_lshlrev_b32 v16, 16, v8
    v_and_b32 v17, 0xffff0000, v8
    v_lshlrev_b32 v18, 16, v9
    v_and_b32 v19, 0xffff0000, v9
    v_lshlrev_b32 v20, 16, v10
    v_and_b32 v21, 0xffff0000, v10
    v_lshlrev_b32 v22, 16, v11
    v_and_b32 v23, 0xffff0000, v11
    v_lshlrev_b32 v24, 16, v12
    v_and_b32 v25, 0xffff0000, v12
    v_add_f32 v40, v16, v17
    v_add_f32 v41, v18, v19
    v_add_f32 v42, v20, v21
    v_add_f32 v43, v22, v23
    v_add_f32 v44, v24, v25
    v_add_f32 v40, v40, v41
    v_add_f32 v42, v42, v43
    v_add_f32 v40, v40, v42
    v_add_f32 v6, v40, v44
    s_nop 1
    v_add_f32_dpp v6, v6, v6 quad_perm:[1,0,3,2] row_mask:0xf bank_mask:0xf
    s_nop 1
    v_add_f32_dpp v6, v6, v6 quad_perm:[2,3,0,1] row_mask:0xf bank_mask:0xf
    s_nop 1
    v_add_f32_dpp v6, v6, v6 row_half_mirror row_mask:0xf bank_mask:0xf
    s_nop 1
    v_add_f32_dpp v6, v6, v6 row_ror:8 row_mask:0xf bank_mask:0xf
    s_nop 1
    v_add_f32_dpp v6, v6, v6 row_bcast:15 row_mask:0xa bank_mask:0xf
    s_nop 1
    v_add_f32_dpp v6, v6, v6 row_bcast:31 row_mask:0xc bank_mask:0xf
    s_nop 0
    v_readlane_b32 s17, v6, 63
    s_nop 1
    v_mov_b32 v6, 0x3acccccd
    v_mul_f32 v6, s17, v6
    v_sub_f32 v40, v16, v6
    v_sub_f32 v41, v17, v6
    v_sub_f32 v42, v18, v6
    v_sub_f32 v43, v19, v6
    v_sub_f32 v44, v20, v6
    v_sub_f32 v45, v21, v6
    v_sub_f32 v46, v22, v6
    v_sub_f32 v47, v23, v6
    v_sub_f32 v48, v24, v6
    v_sub_f32 v49, v25, v6
    v_mul_f32 v40, v40, v40
    v_mul_f32 v41, v41, v41
    v_mul_f32 v42, v42, v42
    v_mul_f32 v43, v43, v43
    v_mul_f32 v44, v44, v44
    v_mul_f32 v45, v45, v45
    v_mul_f32 v46, v46, v46
    v_mul_f32 v47, v47, v47
    v_mul_f32 v48, v48, v48
    v_mul_f32 v49, v49, v49
    v_add_f32 v40, v40, v41
    v_add_f32 v42, v42, v43
    v_add_f32 v44, v44, v45
    v_add_f32 v46, v46, v47
    v_add_f32 v48, v48, v49
    v_add_f32 v40, v40, v42
    v_add_f32 v44, v44, v46
    v_add_f32 v40, v40, v44
    v_add_f32 v7, v40, v48
    s_nop 1
    v_add_f32_dpp v7, v7, v7 quad_perm:[1,0,3,2] row_mask:0xf bank_mask:0xf
    s_nop 1
    v_add_f32_dpp v7, v7, v7 quad_perm:[2,3,0,1] row_mask:0xf bank_mask:0xf
    s_nop 1
    v_add_f32_dpp v7, v7, v7 row_half_mirror row_mask:0xf bank_mask:0xf
    s_nop 1
    v_add_f32_dpp v7, v7, v7 row_ror:8 row_mask:0xf bank_mask:0xf
    s_nop 1
    v_add_f32_dpp v7, v7, v7 row_bcast:15 row_mask:0xa bank_mask:0xf
    s_nop 1
    v_add_f32_dpp v7, v7, v7 row_bcast:31 row_mask:0xc bank_mask:0xf
    s_nop 0
    v_readlane_b32 s18, v7, 63
    s_nop 1
    v_cvt_pk_bf16_f32 v6, v6, v6
    v_lshlrev_b32 v6, 16, v6
    v_mov_b32 v7, 0x3acccccd
    v_mul_f32 v7, s18, v7
    v_sub_f32 v16, v16, v6
    v_sub_f32 v17, v17, v6
    v_sub_f32 v18, v18, v6
    v_sub_f32 v19, v19, v6
    v_sub_f32 v20, v20, v6
    v_sub_f32 v21, v21, v6
    v_sub_f32 v22, v22, v6
    v_sub_f32 v23, v23, v6
    v_sub_f32 v24, v24, v6
    v_sub_f32 v25, v25, v6
    v_cvt_pk_bf16_f32 v7, v7, v7
    v_lshlrev_b32 v7, 16, v7
    v_add_f32 v7, 0x3727c5ac, v7
    v_cvt_pk_bf16_f32 v7, v7, v7
    v_lshlrev_b32 v7, 16, v7
    v_sqrt_f32 v7, v7
    s_nop 0
    v_cvt_pk_bf16_f32 v7, v7, v7
    v_lshlrev_b32 v7, 16, v7
    v_cvt_pk_bf16_f32 v16, v16, v16
    v_cvt_pk_bf16_f32 v17, v17, v17
    v_cvt_pk_bf16_f32 v18, v18, v18
    v_cvt_pk_bf16_f32 v19, v19, v19
    v_cvt_pk_bf16_f32 v20, v20, v20
    v_cvt_pk_bf16_f32 v21, v21, v21
    v_cvt_pk_bf16_f32 v22, v22, v22
    v_cvt_pk_bf16_f32 v23, v23, v23
    v_cvt_pk_bf16_f32 v24, v24, v24
    v_cvt_pk_bf16_f32 v25, v25, v25
    v_rcp_f32 v6, v7
    v_lshlrev_b32 v16, 16, v16
    v_lshlrev_b32 v17, 16, v17
    v_lshlrev_b32 v18, 16, v18
    v_lshlrev_b32 v19, 16, v19
    v_lshlrev_b32 v20, 16, v20
    v_lshlrev_b32 v21, 16, v21
    v_lshlrev_b32 v22, 16, v22
    v_lshlrev_b32 v23, 16, v23
    v_lshlrev_b32 v24, 16, v24
    v_lshlrev_b32 v25, 16, v25
    v_mul_f32 v40, v16, v6
    v_mul_f32 v41, v17, v6
    v_mul_f32 v42, v18, v6
    v_mul_f32 v43, v19, v6
    v_mul_f32 v44, v20, v6
    v_mul_f32 v45, v21, v6
    v_mul_f32 v46, v22, v6
    v_mul_f32 v47, v23, v6
    v_mul_f32 v48, v24, v6
    v_mul_f32 v49, v25, v6
    v_fma_f32 v16, -v40, v7, v16
    v_fma_f32 v17, -v41, v7, v17
    v_fma_f32 v18, -v42, v7, v18
    v_fma_f32 v19, -v43, v7, v19
    v_fma_f32 v20, -v44, v7, v20
    v_fma_f32 v21, -v45, v7, v21
    v_fma_f32 v22, -v46, v7, v22
    v_fma_f32 v23, -v47, v7, v23
    v_fma_f32 v24, -v48, v7, v24
    v_fma_f32 v25, -v49, v7, v25
    v_fma_f32 v40, v16, v6, v40
    v_fma_f32 v41, v17, v6, v41
    v_fma_f32 v42, v18, v6, v42
    v_fma_f32 v43, v19, v6, v43
    v_fma_f32 v44, v20, v6, v44
    v_fma_f32 v45, v21, v6, v45
    v_fma_f32 v46, v22, v6, v46
    v_fma_f32 v47, v23, v6, v47
    v_fma_f32 v48, v24, v6, v48
    v_fma_f32 v49, v25, v6, v49
    v_cvt_pk_bf16_f32 v8, v40, v41
    v_cvt_pk_bf16_f32 v9, v42, v43
    v_cvt_pk_bf16_f32 v10, v44, v45
    v_cvt_pk_bf16_f32 v11, v46, v47
    v_cvt_pk_bf16_f32 v12, v48, v49
    v_add_u32 v7, 157696, v3
    ds_write_b32 v7, v8 offset:0
    ds_write_b32 v7, v9 offset:256
    ds_write_b32 v7, v10 offset:512
    ds_write_b32 v7, v11 offset:768
    ds_write_b32 v7, v12 offset:1024
    v_mov_b32 v1, 1
    ds_write_b32 v2, v1 offset:0
    v_lshrrev_b32 v120, 5, v0
    v_lshlrev_b32 v120, 8, v120
    v_bfe_u32 v121, v0, 2, 2
    v_lshl_add_u32 v120, v121, 6, v120
    v_bfe_u32 v121, v0, 4, 1
    v_lshl_add_u32 v120, v121, 5, v120
    v_and_b32 v121, 3, v0
    v_lshl_add_u32 v120, v121, 3, v120
    s_lshl_b32 s17, s3, 10
    s_add_u32 s17, s17, 116736
    v_add_u32 v120, s17, v120
    s_mul_i32 s95, s8, 3
    s_mul_i32 s19, s12, 10
    s_add_u32 s95, s95, s19
    s_mul_i32 s17, s4, 73728
    s_mul_i32 s18, s5, 2560
    s_add_u32 s17, s17, s18
    s_lshl_b32 s18, s3, 8
    s_add_u32 s17, s17, s18
    s_add_u32 s94, s17, 589824
    v_lshlrev_b32 v121, 2, v0
    v_mov_b32 v122, 160000
    v_lshrrev_b32 v6, 5, v0
    v_lshlrev_b32 v6, 8, v6
    v_bfe_u32 v7, v0, 2, 2
    v_lshl_add_u32 v6, v7, 6, v6
    v_bfe_u32 v7, v0, 4, 1
    v_lshl_add_u32 v6, v7, 5, v6
    v_and_b32 v7, 3, v0
    v_lshl_add_u32 v6, v7, 3, v6
    v_add_u32 v6, 135168, v6
    s_add_u32 s17, s11, 6
    s_lshl_b32 s17, s17, 4
    s_add_u32 s17, s17, 157696
    v_mov_b32 v7, s17
    v_mov_b32 v26, 0
    v_mov_b32 v27, 0
    v_mov_b32 v28, 0
    s_waitcnt vmcnt(12)
    ds_read_b128 v[76:79], v7 offset:0
    ds_read_b64_tr_b16 v[80:81], v6 offset:0
    ds_read_b64_tr_b16 v[82:83], v6 offset:512
    ds_read_b64_tr_b16 v[84:85], v6 offset:1024
    ds_read_b64_tr_b16 v[86:87], v6 offset:1536
    ds_read_b64_tr_b16 v[88:89], v6 offset:2048
    ds_read_b64_tr_b16 v[90:91], v6 offset:2560
    s_waitcnt vmcnt(9)
    ds_read_b128 v[92:95], v7 offset:16
    ds_read_b64_tr_b16 v[96:97], v6 offset:3072
    ds_read_b64_tr_b16 v[98:99], v6 offset:3584
    ds_read_b64_tr_b16 v[100:101], v6 offset:4096
    ds_read_b64_tr_b16 v[102:103], v6 offset:4608
    ds_read_b64_tr_b16 v[104:105], v6 offset:5120
    ds_read_b64_tr_b16 v[106:107], v6 offset:5632
    s_waitcnt lgkmcnt(7)
    v_dot2c_f32_bf16 v26, v80, v76
    v_dot2c_f32_bf16 v27, v84, v76
    v_dot2c_f32_bf16 v28, v88, v76
    v_dot2c_f32_bf16 v26, v81, v77
    v_dot2c_f32_bf16 v27, v85, v77
    v_dot2c_f32_bf16 v28, v89, v77
    v_dot2c_f32_bf16 v26, v82, v78
    v_dot2c_f32_bf16 v27, v86, v78
    v_dot2c_f32_bf16 v28, v90, v78
    v_dot2c_f32_bf16 v26, v83, v79
    v_dot2c_f32_bf16 v27, v87, v79
    v_dot2c_f32_bf16 v28, v91, v79
    s_waitcnt vmcnt(6)
    ds_read_b128 v[76:79], v7 offset:32
    ds_read_b64_tr_b16 v[80:81], v6 offset:6144
    ds_read_b64_tr_b16 v[82:83], v6 offset:6656
    ds_read_b64_tr_b16 v[84:85], v6 offset:7168
    ds_read_b64_tr_b16 v[86:87], v6 offset:7680
    ds_read_b64_tr_b16 v[88:89], v6 offset:8192
    ds_read_b64_tr_b16 v[90:91], v6 offset:8704
    s_waitcnt lgkmcnt(7)
    v_dot2c_f32_bf16 v26, v96, v92
    v_dot2c_f32_bf16 v27, v100, v92
    v_dot2c_f32_bf16 v28, v104, v92
    v_dot2c_f32_bf16 v26, v97, v93
    v_dot2c_f32_bf16 v27, v101, v93
    v_dot2c_f32_bf16 v28, v105, v93
    v_dot2c_f32_bf16 v26, v98, v94
    v_dot2c_f32_bf16 v27, v102, v94
    v_dot2c_f32_bf16 v28, v106, v94
    v_dot2c_f32_bf16 v26, v99, v95
    v_dot2c_f32_bf16 v27, v103, v95
    v_dot2c_f32_bf16 v28, v107, v95
    s_waitcnt vmcnt(3)
    ds_read_b128 v[92:95], v7 offset:48
    ds_read_b64_tr_b16 v[96:97], v6 offset:9216
    ds_read_b64_tr_b16 v[98:99], v6 offset:9728
    ds_read_b64_tr_b16 v[100:101], v6 offset:10240
    ds_read_b64_tr_b16 v[102:103], v6 offset:10752
    ds_read_b64_tr_b16 v[104:105], v6 offset:11264
    ds_read_b64_tr_b16 v[106:107], v6 offset:11776
    s_waitcnt lgkmcnt(7)
    v_dot2c_f32_bf16 v26, v80, v76
    v_dot2c_f32_bf16 v27, v84, v76
    v_dot2c_f32_bf16 v28, v88, v76
    v_dot2c_f32_bf16 v26, v81, v77
    v_dot2c_f32_bf16 v27, v85, v77
    v_dot2c_f32_bf16 v28, v89, v77
    v_dot2c_f32_bf16 v26, v82, v78
    v_dot2c_f32_bf16 v27, v86, v78
    v_dot2c_f32_bf16 v28, v90, v78
    v_dot2c_f32_bf16 v26, v83, v79
    v_dot2c_f32_bf16 v27, v87, v79
    v_dot2c_f32_bf16 v28, v91, v79
    s_waitcnt vmcnt(0)
    ds_read_b128 v[76:79], v7 offset:64
    ds_read_b64_tr_b16 v[80:81], v6 offset:12288
    ds_read_b64_tr_b16 v[82:83], v6 offset:12800
    ds_read_b64_tr_b16 v[84:85], v6 offset:13312
    ds_read_b64_tr_b16 v[86:87], v6 offset:13824
    ds_read_b64_tr_b16 v[88:89], v6 offset:14336
    ds_read_b64_tr_b16 v[90:91], v6 offset:14848
    s_waitcnt lgkmcnt(7)
    v_dot2c_f32_bf16 v26, v96, v92
    v_dot2c_f32_bf16 v27, v100, v92
    v_dot2c_f32_bf16 v28, v104, v92
    v_dot2c_f32_bf16 v26, v97, v93
    v_dot2c_f32_bf16 v27, v101, v93
    v_dot2c_f32_bf16 v28, v105, v93
    v_dot2c_f32_bf16 v26, v98, v94
    v_dot2c_f32_bf16 v27, v102, v94
    v_dot2c_f32_bf16 v28, v106, v94
    v_dot2c_f32_bf16 v26, v99, v95
    v_dot2c_f32_bf16 v27, v103, v95
    v_dot2c_f32_bf16 v28, v107, v95
    s_waitcnt lgkmcnt(0)
    v_dot2c_f32_bf16 v26, v80, v76
    v_dot2c_f32_bf16 v27, v84, v76
    v_dot2c_f32_bf16 v28, v88, v76
    v_dot2c_f32_bf16 v26, v81, v77
    v_dot2c_f32_bf16 v27, v85, v77
    v_dot2c_f32_bf16 v28, v89, v77
    v_dot2c_f32_bf16 v26, v82, v78
    v_dot2c_f32_bf16 v27, v86, v78
    v_dot2c_f32_bf16 v28, v90, v78
    v_dot2c_f32_bf16 v26, v83, v79
    v_dot2c_f32_bf16 v27, v87, v79
    v_dot2c_f32_bf16 v28, v91, v79
    s_cmp_lt_u32 s10, 12
    s_cbranch_scc1 C_115
    s_waitcnt vmcnt(0)
    ds_read_b128 v[92:95], v7 offset:80
    ds_read_b64_tr_b16 v[96:97], v6 offset:15360
    ds_read_b64_tr_b16 v[98:99], v6 offset:15872
    ds_read_b64_tr_b16 v[100:101], v6 offset:16384
    ds_read_b64_tr_b16 v[102:103], v6 offset:16896
    ds_read_b64_tr_b16 v[104:105], v6 offset:17408
    ds_read_b64_tr_b16 v[106:107], v6 offset:17920
    s_waitcnt lgkmcnt(0)
    v_dot2c_f32_bf16 v26, v96, v92
    v_dot2c_f32_bf16 v27, v100, v92
    v_dot2c_f32_bf16 v28, v104, v92
    v_dot2c_f32_bf16 v26, v97, v93
    v_dot2c_f32_bf16 v27, v101, v93
    v_dot2c_f32_bf16 v28, v105, v93
    v_dot2c_f32_bf16 v26, v98, v94
    v_dot2c_f32_bf16 v27, v102, v94
    v_dot2c_f32_bf16 v28, v106, v94
    v_dot2c_f32_bf16 v26, v99, v95
    v_dot2c_f32_bf16 v27, v103, v95
    v_dot2c_f32_bf16 v28, v107, v95
C_115:
    s_nop 2
    v_add_u32 v7, 160256, v4
W_116:
    ds_read_b32 v1, v2 offset:32
    s_waitcnt lgkmcnt(0)
    v_readfirstlane_b32 s16, v1
    s_cmp_ge_u32 s16, 1
    s_cbranch_scc1 WD_117
    s_sub_u32 s14, s14, 1
    s_cbranch_scc1 L_END
    s_branch W_116
WD_117:
    ds_read_b96 v[40:42], v7
    s_waitcnt lgkmcnt(0)
    v_add_f32 v26, v26, v40
    v_add_f32 v27, v27, v41
    v_add_f32 v28, v28, v42
    v_min_u32 v26, -2, v26
    v_min_u32 v27, -2, v27
    v_min_u32 v28, -2, v28
W_118:
    ds_read_b32 v1, v2 offset:44
    s_waitcnt lgkmcnt(0)
    v_readfirstlane_b32 s16, v1
    s_cmp_ge_u32 s16, 1
    s_cbranch_scc1 WD_119
    s_sub_u32 s14, s14, 1
    s_cbranch_scc1 L_END
    s_branch W_118
WD_119:
    s_sub_u32 s15, s16, 1
    s_cmp_lg_u32 s15, 0
    s_cbranch_scc1 SF_120
    buffer_store_dwordx4 v[26:29], v4, s[64:67], s21 offen sc1
    s_branch SD_121
SF_120:
    buffer_store_dwordx4 v[26:29], v4, s[64:67], s21 offen
SD_121:
    buffer_load_dwordx4 v[32:35], v4, s[64:67], s20 offen offset:0 sc1
    buffer_load_dwordx4 v[36:39], v4, s[64:67], s20 offen offset:1024 sc1
    buffer_load_dwordx4 v[40:43], v4, s[64:67], s20 offen offset:2048 sc1
    buffer_load_dwordx4 v[44:47], v4, s[64:67], s20 offen offset:3072 sc1
    buffer_load_dwordx4 v[48:51], v4, s[64:67], s71 offen offset:0 sc1
    buffer_load_dwordx4 v[52:55], v4, s[64:67], s71 offen offset:1024 sc1
    buffer_load_dwordx4 v[56:59], v4, s[64:67], s71 offen offset:2048 sc1
P_122:
    s_waitcnt vmcnt(0)
    v_add_f32 v60, v32, v36
    v_add_f32 v64, v33, v37
    v_add_f32 v68, v34, v38
    v_add_f32 v61, v40, v44
    v_add_f32 v65, v41, v45
    v_add_f32 v69, v42, v46
    v_add_f32 v62, v48, v52
    v_add_f32 v66, v49, v53
    v_add_f32 v70, v50, v54
    v_mov_b32 v63, v56
    v_mov_b32 v67, v57
    v_mov_b32 v71, v58
    v_add_f32 v60, v60, v61
    v_add_f32 v64, v64, v65
    v_add_f32 v68, v68, v69
    v_add_f32 v62, v62, v63
    v_add_f32 v66, v66, v67
    v_add_f32 v70, v70, v71
    v_add_f32 v8, v60, v62
    v_add_f32 v9, v64, v66
    v_add_f32 v10, v68, v70
    v_add_f32 v1, v8, v9
    v_cmp_u_f32 vcc, v1, v10
    s_cmp_eq_u64 vcc, 0
    s_cbranch_scc1 PD_123
    v_max_u32 v1, v32, v33
    v_max3_u32 v1, v1, v34, v36
    v_max3_u32 v1, v1, v37, v38
    v_max3_u32 v1, v1, v40, v41
    v_max3_u32 v1, v1, v42, v44
    v_max3_u32 v1, v1, v45, v46
    v_max3_u32 v1, v1, v48, v49
    v_max3_u32 v1, v1, v50, v52
    v_max3_u32 v1, v1, v53, v54
    v_max3_u32 v1, v1, v56, v57
    v_max_u32 v1, v1, v58
    v_cmp_eq_u32 vcc, -1, v1
    s_cmp_eq_u64 vcc, 0
    s_cbranch_scc1 PD_123
    s_sub_u32 s14, s14, 1
    s_cbranch_scc1 L_END
    buffer_load_dwordx4 v[32:35], v4, s[64:67], s20 offen offset:0 sc1
    buffer_load_dwordx4 v[36:39], v4, s[64:67], s20 offen offset:1024 sc1
    buffer_load_dwordx4 v[40:43], v4, s[64:67], s20 offen offset:2048 sc1
    buffer_load_dwordx4 v[44:47], v4, s[64:67], s20 offen offset:3072 sc1
    buffer_load_dwordx4 v[48:51], v4, s[64:67], s71 offen offset:0 sc1
    buffer_load_dwordx4 v[52:55], v4, s[64:67], s71 offen offset:1024 sc1
    buffer_load_dwordx4 v[56:59], v4, s[64:67], s71 offen offset:2048 sc1
    s_branch P_122
PD_123:
    v_cvt_pk_bf16_f32 v8, v8, v8
    v_cvt_pk_bf16_f32 v9, v9, v9
    v_cvt_pk_bf16_f32 v10, v10, v10
    v_lshlrev_b32 v7, 1, v0
    v_add_u32 v7, 158976, v7
    ds_write_b16 v7, v8 offset:0
    ds_write_b16 v7, v9 offset:128
    ds_write_b16 v7, v10 offset:256
    v_max3_u32 v24, v35, v39, v43
    v_min3_u32 v25, v35, v39, v43
    v_max3_u32 v24, v24, v47, v51
    v_min3_u32 v25, v25, v47, v51
    v_max3_u32 v24, v24, v55, v59
    v_min3_u32 v25, v25, v55, v59
    v_cmp_ne_u32 vcc, v24, v25
    s_cmp_eq_u64 vcc, 0
    s_cselect_b32 s69, 2, 1
    v_mov_b32 v1, s69
    ds_write_b32 v2, v1 offset:8
    s_cmp_eq_u32 s69, 2
    s_cbranch_scc1 RP_124
    buffer_store_dwordx4 v[26:29], v4, s[64:67], s21 offen sc1
RP_124:
    v_lshrrev_b32 v7, 3, v0
    v_lshlrev_b32 v7, 7, v7
    v_and_b32 v8, 7, v0
    v_lshl_add_u32 v7, v8, 3, v7
    s_lshl_b32 s17, s6, 10
    s_add_u32 s69, s17, 262144
    v_mov_b32 v8, 0xff800000
    v_mov_b32 v9, 0
W_125:
    ds_read_b32 v1, v2 offset:40
    s_waitcnt lgkmcnt(0)
    v_readfirstlane_b32 s16, v1
    s_cmp_ge_u32 s16, 7
    s_cbranch_scc1 WD_126
    s_sleep 1
    s_sub_u32 s14, s14, 1
    s_cbranch_scc1 L_END
    s_branch W_125
WD_126:
    s_mov_b32 exec_lo, -1
    s_mov_b32 exec_hi, 0xffffff
    buffer_load_dwordx2 v[12:13], v7, s[64:67], s69 offen sc1
    s_sleep 8
    buffer_load_dwordx2 v[14:15], v7, s[64:67], s69 offen sc1
    s_sleep 8
    buffer_load_dwordx2 v[16:17], v7, s[64:67], s69 offen sc1
P_127:
    s_waitcnt vmcnt(2)
    v_mov_b32 v8, v12
    v_mov_b32 v9, v13
    v_cmp_u_f32 vcc, v8, v9
    s_cmp_eq_u64 vcc, 0
    s_cbranch_scc1 PD_128
    v_max_u32 v1, v12, v13
    v_cmp_eq_u32 vcc, -1, v1
    s_cmp_eq_u64 vcc, 0
    s_cbranch_scc1 PD_128
    s_sub_u32 s14, s14, 1
    s_cbranch_scc1 L_END
    buffer_load_dwordx2 v[12:13], v7, s[64:67], s69 offen sc1
    s_waitcnt vmcnt(2)
    v_mov_b32 v8, v14
    v_mov_b32 v9, v15
    v_cmp_u_f32 vcc, v8, v9
    s_cmp_eq_u64 vcc, 0
    s_cbranch_scc1 PD_128
    v_max_u32 v1, v14, v15
    v_cmp_eq_u32 vcc, -1, v1
    s_cmp_eq_u64 vcc, 0
    s_cbranch_scc1 PD_128
    s_sub_u32 s14, s14, 1
    s_cbranch_scc1 L_END
    buffer_load_dwordx2 v[14:15], v7, s[64:67], s69 offen sc1
    s_waitcnt vmcnt(2)
    v_mov_b32 v8, v16
    v_mov_b32 v9, v17
    v_cmp_u_f32 vcc, v8, v9
    s_cmp_eq_u64 vcc, 0
    s_cbranch_scc1 PD_128
    v_max_u32 v1, v16, v17
    v_cmp_eq_u32 vcc, -1, v1
    s_cmp_eq_u64 vcc, 0
    s_cbranch_scc1 PD_128
    s_sub_u32 s14, s14, 1
    s_cbranch_scc1 L_END
    buffer_load_dwordx2 v[16:17], v7, s[64:67], s69 offen sc1
    s_branch P_127
PD_128:
    s_mov_b64 exec, -1
    v_mov_b32 v10, v8
    s_nop 1
    v_max_f32_dpp v10, v10, v10 quad_perm:[1,0,3,2] row_mask:0xf bank_mask:0xf
    s_nop 1
    v_max_f32_dpp v10, v10, v10 quad_perm:[2,3,0,1] row_mask:0xf bank_mask:0xf
    s_nop 1
    v_max_f32_dpp v10, v10, v10 row_half_mirror row_mask:0xf bank_mask:0xf
    s_nop 1
    v_max_f32_dpp v10, v10, v10 row_ror:8 row_mask:0xf bank_mask:0xf
    s_nop 1
    v_max_f32_dpp v10, v10, v10 row_bcast:15 row_mask:0xa bank_mask:0xf
    s_nop 1
    v_max_f32_dpp v10, v10, v10 row_bcast:31 row_mask:0xc bank_mask:0xf
    s_nop 0
    v_readlane_b32 s18, v10, 63
    s_nop 1
    s_mov_b32 s17, 0x3fb8aa3b
    v_subrev_f32 v10, s18, v8
    v_mul_f32 v10, s17, v10
    v_exp_f32 v10, v10
    s_nop 0
    v_mul_f32 v10, v10, v9
    s_nop 1
    v_add_f32_dpp v10, v10, v10 quad_perm:[1,0,3,2] row_mask:0xf bank_mask:0xf
    s_nop 1
    v_add_f32_dpp v10, v10, v10 quad_perm:[2,3,0,1] row_mask:0xf bank_mask:0xf
    s_nop 1
    v_add_f32_dpp v10, v10, v10 row_half_mirror row_mask:0xf bank_mask:0xf
    s_nop 1
    v_add_f32_dpp v10, v10, v10 row_ror:8 row_mask:0xf bank_mask:0xf
    s_nop 1
    v_add_f32_dpp v10, v10, v10 row_bcast:15 row_mask:0xa bank_mask:0xf
    s_nop 1
    v_add_f32_dpp v10, v10, v10 row_bcast:31 row_mask:0xc bank_mask:0xf
    s_nop 0
    v_readlane_b32 s19, v10, 63
    s_nop 1
    v_rcp_f32 v11, s19
    s_nop 0
    v_fma_f32 v10, -v11, s19, 1.0
    v_fma_f32 v11, v10, v11, v11
    v_mov_b32 v10, s18
    ds_write_b64 v2, v[10:11] offset:16
    v_mov_b32 v1, 1
    ds_write_b32 v2, v1 offset:24
    s_lshl_b32 s17, s13, 3
    v_add_u32 v7, s17, v0
    v_and_b32 v8, 63, v7
    v_mul_u32_u24 v8, 12, v8
    v_lshrrev_b32 v7, 6, v7
    v_lshl_add_u32 v7, v7, 2, v8
    s_add_u32 s69, s20, 327680
    s_add_u32 s70, s69, 3072
    v_lshlrev_b32 v9, 1, v0
    v_add_u32 v9, 160000, v9
    v_lshrrev_b32 v100, 5, v0
    v_mul_u32_u24 v100, 35840, v100
    v_and_b32 v8, 31, v0
    v_lshl_add_u32 v100, v8, 2, v100
    v_add_u32 v101, 2560, v100
    v_add_u32 v102, 5120, v100
    v_add_u32 v103, 7680, v100
    v_add_u32 v104, 10240, v100
    v_add_u32 v105, 12800, v100
    v_add_u32 v106, 15360, v100
    v_add_u32 v107, 17920, v100
    v_add_u32 v108, 20480, v100
    v_add_u32 v109, 23040, v100
    v_add_u32 v110, 25600, v100
    v_add_u32 v111, 28160, v100
    v_add_u32 v112, 30720, v100
    v_add_u32 v113, 33280, v100
    s_mul_i32 s17, s4, 73728
    s_lshl_b32 s18, s5, 7
    s_add_u32 s17, s17, s18
    s_add_u32 s71, s17, 589824
    s_lshl_b32 s23, s4, 12
    s_add_u32 s23, s23, s18
    s_add_u32 s23, s23, 1179648
W_129:
    ds_read_b32 v1, v2 offset:12
    s_waitcnt lgkmcnt(0)
    v_readfirstlane_b32 s16, v1
    s_cmp_ge_u32 s16, 6
    s_cbranch_scc1 WD_130
    s_sleep 1
    s_sub_u32 s14, s14, 1
    s_cbranch_scc1 L_END
    s_branch W_129
WD_130:
    s_cmp_lt_u32 s12, 4
    s_cselect_b32 exec_lo, 0xffffff, -1
    s_mov_b32 exec_hi, 0
    buffer_load_dword v32, v7, s[64:67], s69 offen offset:0 sc1
    buffer_load_dword v33, v7, s[64:67], s69 offen offset:768 sc1
    buffer_load_dword v34, v7, s[64:67], s69 offen offset:1536 sc1
    buffer_load_dword v35, v7, s[64:67], s69 offen offset:2304 sc1
    buffer_load_dword v36, v7, s[64:67], s70 offen offset:0 sc1
    buffer_load_dword v37, v7, s[64:67], s70 offen offset:768 sc1
    buffer_load_dword v38, v7, s[64:67], s70 offen offset:1536 sc1
    s_sleep 8
    buffer_load_dword v40, v7, s[64:67], s69 offen offset:0 sc1
    buffer_load_dword v41, v7, s[64:67], s69 offen offset:768 sc1
    buffer_load_dword v42, v7, s[64:67], s69 offen offset:1536 sc1
    buffer_load_dword v43, v7, s[64:67], s69 offen offset:2304 sc1
    buffer_load_dword v44, v7, s[64:67], s70 offen offset:0 sc1
    buffer_load_dword v45, v7, s[64:67], s70 offen offset:768 sc1
    buffer_load_dword v46, v7, s[64:67], s70 offen offset:1536 sc1
P_131:
    s_waitcnt vmcnt(7)
    v_add_f32 v20, v32, v33
    v_add_f32 v21, v34, v35
    v_add_f32 v22, v36, v37
    v_mov_b32 v23, v38
    v_add_f32 v20, v20, v21
    v_add_f32 v22, v22, v23
    v_add_f32 v8, v20, v22
    v_cmp_u_f32 vcc, v8, v8
    s_cmp_eq_u64 vcc, 0
    s_cbranch_scc1 PD_132
    v_max_u32 v1, v32, v33
    v_max3_u32 v1, v1, v34, v35
    v_max3_u32 v1, v1, v36, v37
    v_max_u32 v1, v1, v38
    v_cmp_eq_u32 vcc, -1, v1
    s_cmp_eq_u64 vcc, 0
    s_cbranch_scc1 PD_132
    s_sub_u32 s14, s14, 1
    s_cbranch_scc1 L_END
    buffer_load_dword v32, v7, s[64:67], s69 offen offset:0 sc1
    buffer_load_dword v33, v7, s[64:67], s69 offen offset:768 sc1
    buffer_load_dword v34, v7, s[64:67], s69 offen offset:1536 sc1
    buffer_load_dword v35, v7, s[64:67], s69 offen offset:2304 sc1
    buffer_load_dword v36, v7, s[64:67], s70 offen offset:0 sc1
    buffer_load_dword v37, v7, s[64:67], s70 offen offset:768 sc1
    buffer_load_dword v38, v7, s[64:67], s70 offen offset:1536 sc1
    s_waitcnt vmcnt(7)
    v_add_f32 v20, v40, v41
    v_add_f32 v21, v42, v43
    v_add_f32 v22, v44, v45
    v_mov_b32 v23, v46
    v_add_f32 v20, v20, v21
    v_add_f32 v22, v22, v23
    v_add_f32 v8, v20, v22
    v_cmp_u_f32 vcc, v8, v8
    s_cmp_eq_u64 vcc, 0
    s_cbranch_scc1 PD_132
    v_max_u32 v1, v40, v41
    v_max3_u32 v1, v1, v42, v43
    v_max3_u32 v1, v1, v44, v45
    v_max_u32 v1, v1, v46
    v_cmp_eq_u32 vcc, -1, v1
    s_cmp_eq_u64 vcc, 0
    s_cbranch_scc1 PD_132
    s_sub_u32 s14, s14, 1
    s_cbranch_scc1 L_END
    buffer_load_dword v40, v7, s[64:67], s69 offen offset:0 sc1
    buffer_load_dword v41, v7, s[64:67], s69 offen offset:768 sc1
    buffer_load_dword v42, v7, s[64:67], s69 offen offset:1536 sc1
    buffer_load_dword v43, v7, s[64:67], s69 offen offset:2304 sc1
    buffer_load_dword v44, v7, s[64:67], s70 offen offset:0 sc1
    buffer_load_dword v45, v7, s[64:67], s70 offen offset:768 sc1
    buffer_load_dword v46, v7, s[64:67], s70 offen offset:1536 sc1
    s_branch P_131
PD_132:
    s_nop 1
    v_mov_b32_dpp v10, v8 quad_perm:[1,1,3,3] row_mask:0xf bank_mask:0xf
    s_and_b32 exec_lo, exec_lo, 0x55555555
    v_cvt_pk_bf16_f32 v8, v8, v10
    v_min_u32 v8, -2, v8
    ds_write_b32 v9, v8
    s_mov_b64 exec, -1
W_133:
    ds_read_b32 v1, v2 offset:28
    s_waitcnt lgkmcnt(0)
    v_readfirstlane_b32 s16, v1
    s_cmp_ge_u32 s16, s95
    s_cbranch_scc1 WD_134
    s_sub_u32 s14, s14, 1
    s_cbranch_scc1 L_END
    s_branch W_133
WD_134:
    ds_read_b64_tr_b16 v[124:125], v120 offset:0
    ds_read_b64_tr_b16 v[126:127], v120 offset:512
    ds_read_b64_tr_b16 v[128:129], v120 offset:10240
    ds_read_b64_tr_b16 v[130:131], v120 offset:10752
    ds_read_b64_tr_b16 v[132:133], v120 offset:20480
    ds_read_b64_tr_b16 v[134:135], v120 offset:20992
    v_mov_b32 v156, 0
    v_mov_b32 v157, 0
    v_mov_b32 v158, 0
    v_mov_b32 v159, 0
    s_cmp_lt_u32 s12, 4
    s_cbranch_scc1 WS_135
    ds_read_b64_tr_b16 v[136:137], v120 offset:30720
    ds_read_b64_tr_b16 v[138:139], v120 offset:31232
WS_135:
W_136:
    ds_read_b32 v1, v2 offset:36
    s_waitcnt lgkmcnt(0)
    v_readfirstlane_b32 s16, v1
    s_cmp_ge_u32 s16, 1
    s_cbranch_scc1 WD_137
    s_sub_u32 s14, s14, 1
    s_cbranch_scc1 L_END
    s_branch W_136
WD_137:
    s_sub_u32 s15, s16, 1
WO_138:
    ds_read_b128 v[140:143], v122 offset:0
    ds_read_b128 v[144:147], v122 offset:16
    ds_read_b128 v[148:151], v122 offset:32
    ds_read_b128 v[152:155], v122 offset:48
    s_waitcnt lgkmcnt(0)
    v_max3_u32 v1, v140, v144, v148
    v_max_u32 v1, v1, v152
    v_cmp_eq_u32 vcc, -1, v1
    s_cbranch_vccz WOD_139
    s_sub_u32 s14, s14, 1
    s_cbranch_scc1 L_END
    s_branch WO_138
WOD_139:
    s_cmp_lt_u32 s12, 4
    s_cbranch_scc1 WS_140
    v_dot2c_f32_bf16 v156, v124, v140
    v_dot2c_f32_bf16 v157, v128, v144
    v_dot2c_f32_bf16 v158, v132, v148
    v_dot2c_f32_bf16 v159, v136, v152
    v_dot2c_f32_bf16 v156, v125, v141
    v_dot2c_f32_bf16 v157, v129, v145
    v_dot2c_f32_bf16 v158, v133, v149
    v_dot2c_f32_bf16 v159, v137, v153
    v_dot2c_f32_bf16 v156, v126, v142
    v_dot2c_f32_bf16 v157, v130, v146
    v_dot2c_f32_bf16 v158, v134, v150
    v_dot2c_f32_bf16 v159, v138, v154
    v_dot2c_f32_bf16 v156, v127, v143
    v_dot2c_f32_bf16 v157, v131, v147
    v_dot2c_f32_bf16 v158, v135, v151
    v_dot2c_f32_bf16 v159, v139, v155
    s_branch WS_141
WS_140:
    v_dot2c_f32_bf16 v156, v124, v140
    v_dot2c_f32_bf16 v157, v128, v144
    v_dot2c_f32_bf16 v158, v132, v148
    v_dot2c_f32_bf16 v156, v125, v141
    v_dot2c_f32_bf16 v157, v129, v145
    v_dot2c_f32_bf16 v158, v133, v149
    v_dot2c_f32_bf16 v156, v126, v142
    v_dot2c_f32_bf16 v157, v130, v146
    v_dot2c_f32_bf16 v158, v134, v150
    v_dot2c_f32_bf16 v156, v127, v143
    v_dot2c_f32_bf16 v157, v131, v147
    v_dot2c_f32_bf16 v158, v135, v151
WS_141:
    s_nop 1
    v_add_f32 v156, v156, v157
    v_add_f32 v158, v158, v159
    v_add_f32 v156, v156, v158
    v_min_u32 v156, -2, v156
    s_cmp_lg_u32 s15, 0
    s_cbranch_scc1 SF_142
    buffer_store_dword v156, v121, s[64:67], s94 offen sc1
    s_branch SD_143
SF_142:
    buffer_store_dword v156, v121, s[64:67], s94 offen
SD_143:
    s_cmp_ge_u32 s5, 20
    s_cbranch_scc1 L_END
    buffer_load_dword v32, v100, s[64:67], s71 offen sc1
    buffer_load_dword v33, v101, s[64:67], s71 offen sc1
    buffer_load_dword v34, v102, s[64:67], s71 offen sc1
    buffer_load_dword v35, v103, s[64:67], s71 offen sc1
    buffer_load_dword v36, v104, s[64:67], s71 offen sc1
    buffer_load_dword v37, v105, s[64:67], s71 offen sc1
    buffer_load_dword v38, v106, s[64:67], s71 offen sc1
    buffer_load_dword v39, v107, s[64:67], s71 offen sc1
    buffer_load_dword v40, v108, s[64:67], s71 offen sc1
    buffer_load_dword v41, v109, s[64:67], s71 offen sc1
    buffer_load_dword v42, v110, s[64:67], s71 offen sc1
    buffer_load_dword v43, v111, s[64:67], s71 offen sc1
    buffer_load_dword v44, v112, s[64:67], s71 offen sc1
    buffer_load_dword v45, v113, s[64:67], s71 offen sc1
    s_sleep 1
    buffer_load_dword v46, v100, s[64:67], s71 offen sc1
    buffer_load_dword v47, v101, s[64:67], s71 offen sc1
    buffer_load_dword v48, v102, s[64:67], s71 offen sc1
    buffer_load_dword v49, v103, s[64:67], s71 offen sc1
    buffer_load_dword v50, v104, s[64:67], s71 offen sc1
    buffer_load_dword v51, v105, s[64:67], s71 offen sc1
    buffer_load_dword v52, v106, s[64:67], s71 offen sc1
    buffer_load_dword v53, v107, s[64:67], s71 offen sc1
    buffer_load_dword v54, v108, s[64:67], s71 offen sc1
    buffer_load_dword v55, v109, s[64:67], s71 offen sc1
    buffer_load_dword v56, v110, s[64:67], s71 offen sc1
    buffer_load_dword v57, v111, s[64:67], s71 offen sc1
    buffer_load_dword v58, v112, s[64:67], s71 offen sc1
    buffer_load_dword v59, v113, s[64:67], s71 offen sc1
P_144:
    s_waitcnt vmcnt(14)
    v_add_f32 v20, v32, v33
    v_add_f32 v21, v34, v35
    v_add_f32 v22, v36, v37
    v_add_f32 v23, v38, v39
    v_add_f32 v24, v40, v41
    v_add_f32 v25, v42, v43
    v_add_f32 v26, v44, v45
    v_add_f32 v20, v20, v21
    v_add_f32 v22, v22, v23
    v_add_f32 v24, v24, v25
    v_add_f32 v20, v20, v22
    v_add_f32 v24, v24, v26
    v_add_f32 v8, v20, v24
    v_cmp_u_f32 vcc, v8, v8
    s_cmp_eq_u64 vcc, 0
    s_cbranch_scc1 PD_145
    v_max_u32 v1, v32, v33
    v_max3_u32 v1, v1, v34, v35
    v_max3_u32 v1, v1, v36, v37
    v_max3_u32 v1, v1, v38, v39
    v_max3_u32 v1, v1, v40, v41
    v_max3_u32 v1, v1, v42, v43
    v_max3_u32 v1, v1, v44, v45
    v_cmp_eq_u32 vcc, -1, v1
    s_cmp_eq_u64 vcc, 0
    s_cbranch_scc1 PD_145
    s_sub_u32 s14, s14, 1
    s_cbranch_scc1 L_END
    buffer_load_dword v32, v100, s[64:67], s71 offen sc1
    buffer_load_dword v33, v101, s[64:67], s71 offen sc1
    buffer_load_dword v34, v102, s[64:67], s71 offen sc1
    buffer_load_dword v35, v103, s[64:67], s71 offen sc1
    buffer_load_dword v36, v104, s[64:67], s71 offen sc1
    buffer_load_dword v37, v105, s[64:67], s71 offen sc1
    buffer_load_dword v38, v106, s[64:67], s71 offen sc1
    buffer_load_dword v39, v107, s[64:67], s71 offen sc1
    buffer_load_dword v40, v108, s[64:67], s71 offen sc1
    buffer_load_dword v41, v109, s[64:67], s71 offen sc1
    buffer_load_dword v42, v110, s[64:67], s71 offen sc1
    buffer_load_dword v43, v111, s[64:67], s71 offen sc1
    buffer_load_dword v44, v112, s[64:67], s71 offen sc1
    buffer_load_dword v45, v113, s[64:67], s71 offen sc1
    s_waitcnt vmcnt(14)
    v_add_f32 v20, v46, v47
    v_add_f32 v21, v48, v49
    v_add_f32 v22, v50, v51
    v_add_f32 v23, v52, v53
    v_add_f32 v24, v54, v55
    v_add_f32 v25, v56, v57
    v_add_f32 v26, v58, v59
    v_add_f32 v20, v20, v21
    v_add_f32 v22, v22, v23
    v_add_f32 v24, v24, v25
    v_add_f32 v20, v20, v22
    v_add_f32 v24, v24, v26
    v_add_f32 v8, v20, v24
    v_cmp_u_f32 vcc, v8, v8
    s_cmp_eq_u64 vcc, 0
    s_cbranch_scc1 PD_145
    v_max_u32 v1, v46, v47
    v_max3_u32 v1, v1, v48, v49
    v_max3_u32 v1, v1, v50, v51
    v_max3_u32 v1, v1, v52, v53
    v_max3_u32 v1, v1, v54, v55
    v_max3_u32 v1, v1, v56, v57
    v_max3_u32 v1, v1, v58, v59
    v_cmp_eq_u32 vcc, -1, v1
    s_cmp_eq_u64 vcc, 0
    s_cbranch_scc1 PD_145
    s_sub_u32 s14, s14, 1
    s_cbranch_scc1 L_END
    buffer_load_dword v46, v100, s[64:67], s71 offen sc1
    buffer_load_dword v47, v101, s[64:67], s71 offen sc1
    buffer_load_dword v48, v102, s[64:67], s71 offen sc1
    buffer_load_dword v49, v103, s[64:67], s71 offen sc1
    buffer_load_dword v50, v104, s[64:67], s71 offen sc1
    buffer_load_dword v51, v105, s[64:67], s71 offen sc1
    buffer_load_dword v52, v106, s[64:67], s71 offen sc1
    buffer_load_dword v53, v107, s[64:67], s71 offen sc1
    buffer_load_dword v54, v108, s[64:67], s71 offen sc1
    buffer_load_dword v55, v109, s[64:67], s71 offen sc1
    buffer_load_dword v56, v110, s[64:67], s71 offen sc1
    buffer_load_dword v57, v111, s[64:67], s71 offen sc1
    buffer_load_dword v58, v112, s[64:67], s71 offen sc1
    buffer_load_dword v59, v113, s[64:67], s71 offen sc1
    s_branch P_144
PD_145:
    v_mov_b32 v9, v8
    s_nop 1
    v_permlane32_swap_b32 v8, v9
    s_nop 1
    v_add_f32 v8, v8, v9
    v_min_u32 v8, -2, v8
    s_mov_b32 exec_lo, 0xffffffff
    s_mov_b32 exec_hi, 0
    buffer_store_dword v8, v121, s[64:67], s23 offen sc1
    s_mov_b64 exec, -1
    s_branch L_END
L_END:
L_END0:
    s_endpgm
.section .rodata,"a"
.p2align 6
.amdhsa_kernel sequential_preLN__sliding_block_cached__glu_gated_glu__decode_kernel
  .amdhsa_next_free_vgpr 168
  .amdhsa_next_free_sgpr 102
  .amdhsa_accum_offset 168
  .amdhsa_group_segment_fixed_size 0
  .amdhsa_kernarg_size 96
  .amdhsa_user_sgpr_count 2
  .amdhsa_user_sgpr_kernarg_segment_ptr 1
  .amdhsa_system_sgpr_workgroup_id_x 1
  .amdhsa_float_denorm_mode_32 3
.end_amdhsa_kernel
```
